```python
import torch

def _softmax(x, axis=-1):
    return torch.softmax(x, dim=axis)
def _gelu(x):
    return torch.nn.functional.gelu(x, approximate="tanh")
def _silu(x):
    return torch.nn.functional.silu(x)
def _sigmoid(x):
    return torch.sigmoid(x)
def _layernorm(x, axis=-1, eps=1e-5):
    m = x.mean(dim=axis, keepdim=True)
    v = x.var(dim=axis, keepdim=True, unbiased=False)
    return (x - m) / torch.sqrt(v + eps)
def _scatter_add(tgt, idx, src, axis=0):
    return tgt.clone().index_add_(axis, idx, src)
def _segment_sum(src, seg, n):
    out = torch.zeros((n,) + src.shape[1:], dtype=src.dtype)
    return out.index_add_(0, seg, src)
def _pad(x, pw):
    flat = tuple(v for pair in reversed(pw) for v in pair)
    return torch.nn.functional.pad(x, flat)

kernel_name = 'standalone__glu_gated_reglu__prompt'

def setup_inputs():

    _w = (lambda a: (lambda t: t.to(torch.bfloat16) if t.is_floating_point() else t)(torch.as_tensor(a)))
    B, S, D, F = 1, 2048, 512, 1792
    return {
        "x": _w((lambda *s: torch.randn(*s, dtype=torch.bfloat16) * 0.05)(B, S, D)),
        "W_gate": _w((lambda *s: torch.randn(*s, dtype=torch.bfloat16) * 0.05)(D, F) * (2.0 / D) ** 0.5),
        "W_up": _w((lambda *s: torch.randn(*s, dtype=torch.bfloat16) * 0.05)(D, F) * (2.0 / D) ** 0.5),
        "W_down": _w((lambda *s: torch.randn(*s, dtype=torch.bfloat16) * 0.05)(F, D) * (1.0 / F) ** 0.5),
    }

def reference(x, W_gate, W_up, W_down):
    gate = torch.einsum("bsd,df->bsf", x, W_gate)
    up = torch.einsum("bsd,df->bsf", x, W_up)
    gate = gate * (lambda x, dt: x.to(dt))(gate > 0, gate.dtype)
    h = gate * up
    return torch.einsum("bsf,fd->bsd", h, W_down)
```

```asm
; @launch grid=(256,1,1) block=(512,1,1) lds=163840
.amdgcn_target "amdgcn-amd-amdhsa--gfx950"
.text
.globl standalone__glu_gated_reglu__prompt_kernel
.p2align 8
.type standalone__glu_gated_reglu__prompt_kernel,@function
standalone__glu_gated_reglu__prompt_kernel:
    s_cmp_ge_u32 s2, 256
    s_cbranch_scc1 L_end
    s_load_dwordx2 s[8:9], s[0:1], 0
    s_load_dwordx2 s[12:13], s[0:1], 8
    s_load_dwordx2 s[16:17], s[0:1], 16
    s_load_dwordx2 s[20:21], s[0:1], 24
    s_load_dwordx2 s[24:25], s[0:1], 32
    s_load_dwordx2 s[32:33], s[0:1], 40
    s_load_dwordx2 s[28:29], s[0:1], 48
    s_mov_b32 s10, 2097152
    s_mov_b32 s11, 0x00020000
    s_mov_b32 s14, 1835008
    s_mov_b32 s15, 0x00020000
    s_mov_b32 s18, 1835008
    s_mov_b32 s19, 0x00020000
    s_mov_b32 s22, 1835008
    s_mov_b32 s23, 0x00020000
    s_mov_b32 s26, 2097152
    s_mov_b32 s27, 0x00020000
    s_mov_b32 s30, 7356416
    s_mov_b32 s31, 0x00020000
    v_lshrrev_b32 v1, 6, v0
    v_and_b32 v2, 63, v0
    v_readfirstlane_b32 s36, v1
    s_and_b32 s34, s2, 7
    s_lshr_b32 s35, s2, 3
    s_and_b32 s56, s34, 3
    s_mul_i32 s56, s56, 28
    s_add_u32 s56, s56, s35
    s_lshr_b32 s38, s56, 3
    s_and_b32 s37, s56, 7
    s_and_b32 s57, s34, 4
    s_lshl_b32 s57, s57, 1
    s_add_u32 s37, s37, s57
    s_lshl_b32 s44, s38, 1
    s_add_u32 s44, s44, s37
    s_and_b32 s44, s44, 7
    s_lshl_b32 s4, s37, 17
    s_lshl_b32 s5, s38, 7
    s_lshl_b32 s40, s44, 7
    s_add_u32 s40, s40, s4
    s_mul_i32 s41, s44, 229376
    s_add_u32 s41, s41, s5
    s_lshl_b32 s42, s36, 10
    v_lshrrev_b32 v3, 3, v2
    v_and_b32 v4, 7, v2
    v_lshrrev_b32 v5, 4, v2
    v_and_b32 v6, 1, v1
    v_lshl_add_u32 v7, v6, 2, v5
    v_xor_b32 v7, v4, v7
    v_lshlrev_b32 v7, 4, v7
    v_lshl_add_u32 v7, v3, 10, v7
    v_lshl_add_u32 v10, v1, 13, v7
    v_add_u32 v11, 0x10000, v10
    v_lshl_add_u32 v7, v1, 3, v3
    s_movk_i32 s39, 3584
    v_mul_lo_u32 v7, v7, s39
    v_and_b32 v5, 1, v5
    v_lshl_add_u32 v5, v6, 1, v5
    v_lshlrev_b32 v5, 1, v5
    v_xor_b32 v5, v5, v4
    v_lshl_add_u32 v12, v5, 4, v7
    s_cmp_ge_u32 s35, 28
    s_cbranch_scc1 L_p2only
    s_waitcnt lgkmcnt(0)
    s_add_u32 m0, s42, 0
    s_nop 0
    buffer_load_dwordx4 v10, s[8:11], s40 offen lds
    s_add_u32 m0, s42, 16384
    s_nop 0
    buffer_load_dwordx4 v12, s[12:15], s41 offen lds
    s_add_u32 m0, s42, 24576
    s_nop 0
    buffer_load_dwordx4 v12, s[16:19], s41 offen lds
    s_add_u32 m0, s42, 8192
    s_nop 0
    buffer_load_dwordx4 v11, s[8:11], s40 offen lds
    s_add_u32 s44, s44, 1
    s_and_b32 s44, s44, 7
    s_lshl_b32 s40, s44, 7
    s_add_u32 s40, s40, s4
    s_mul_i32 s41, s44, 229376
    s_add_u32 s41, s41, s5
    s_barrier
    s_add_u32 m0, s42, 32768
    s_nop 0
    buffer_load_dwordx4 v10, s[8:11], s40 offen lds
    s_add_u32 m0, s42, 49152
    s_nop 0
    buffer_load_dwordx4 v12, s[12:15], s41 offen lds
    s_add_u32 m0, s42, 57344
    s_nop 0
    buffer_load_dwordx4 v12, s[16:19], s41 offen lds
    s_add_u32 m0, s42, 40960
    s_nop 0
    buffer_load_dwordx4 v11, s[8:11], s40 offen lds
    s_add_u32 s44, s44, 1
    s_and_b32 s44, s44, 7
    s_lshl_b32 s40, s44, 7
    s_add_u32 s40, s40, s4
    s_mul_i32 s41, s44, 229376
    s_add_u32 s41, s41, s5
    v_and_b32 v3, 15, v2
    v_lshrrev_b32 v4, 4, v2
    v_bfe_u32 v5, v2, 1, 3
    v_xor_b32 v5, v5, v4
    v_and_b32 v6, 3, v1
    v_lshl_add_u32 v6, v6, 5, v3
    v_lshlrev_b32 v6, 7, v6
    v_lshl_add_u32 v26, v5, 4, v6
    v_xor_b32 v27, 64, v26
    v_bfe_u32 v5, v2, 2, 2
    v_lshl_add_u32 v6, v4, 3, v5
    v_lshlrev_b32 v6, 7, v6
    v_and_b32 v7, 3, v2
    v_lshl_add_u32 v6, v7, 3, v6
    v_bfe_u32 v5, v2, 3, 2
    v_lshrrev_b32 v7, 2, v1
    v_xor_b32 v5, v5, v7
    v_lshl_add_u32 v20, v5, 5, v6
    v_xor_b32 v21, 64, v20
    v_add_u32 v22, 0x10000, v20
    v_add_u32 v28, 0x10000, v26
    v_add_u32 v23, 0x10000, v21
    v_add_u32 v29, 0x10000, v27
    v_add_u32 v24, 0x20000, v20
    v_add_u32 v30, 0x20000, v26
    v_add_u32 v25, 0x20000, v21
    v_add_u32 v31, 0x20000, v27
    s_lshl_b32 s56, s37, 2
    s_and_b32 s57, s36, 3
    s_add_u32 s56, s56, s57
    s_lshl_b32 s57, s38, 1
    s_lshr_b32 s58, s36, 2
    s_mul_i32 s45, s56, 56
    s_add_u32 s45, s45, s57
    s_lshl_b32 s45, s45, 2
    s_add_u32 s45, s45, s58
    s_lshl_b32 s45, s45, 9
    s_add_u32 s46, s45, 57344
    s_lshl_b32 s56, s56, 5
    s_add_u32 s57, s57, s58
    s_add_u32 s49, s56, s57
    s_lshl_b32 s49, s49, 2
    s_add_u32 s49, s49, 7340032
    s_lshr_b32 s52, s35, 3
    s_lshl_b32 s56, s34, 2
    s_add_u32 s52, s52, s56
    s_and_b32 s53, s35, 7
    s_and_b32 s54, s36, 1
    s_lshr_b32 s55, s36, 1
    s_lshr_b32 s56, s35, 3
    s_lshl_b32 s56, s56, 1
    s_add_u32 s56, s56, s53
    s_sub_u32 s57, s56, 7
    s_cmp_ge_u32 s56, 7
    s_cselect_b32 s56, s57, s56
    s_sub_u32 s6, 7, s56
    s_mul_i32 s57, s55, 7
    s_add_u32 s57, s57, s56
    s_lshl_b32 s43, s57, 15
    s_lshl_b32 s56, s54, 14
    s_lshl_b32 s38, s53, 7
    s_add_u32 s38, s38, s56
    s_add_u32 s43, s43, s38
    s_and_b32 s101, s55, 1
    s_mul_i32 s58, s55, 7
    s_add_u32 s37, s58, s101
    s_add_u32 s37, s37, 28
    s_lshl_b32 s56, s37, 15
    s_add_u32 s38, s38, s56
    s_mul_i32 s101, s101, 7
    s_lshl_b32 s56, s52, 1
    s_add_u32 s56, s56, s54
    s_mul_i32 s3, s56, 56
    s_add_u32 s37, s37, s3
    s_lshl_b32 s37, s37, 11
    s_add_u32 s3, s3, s57
    s_lshl_b32 s3, s3, 11
    s_lshr_b32 s58, s58, 1
    s_lshl_b32 s50, s56, 4
    s_add_u32 s50, s50, s58
    s_lshl_b32 s50, s50, 3
    s_add_u32 s50, s50, 7340032
    s_lshl_b32 s52, s56, 15
    s_lshl_b32 s53, s53, 7
    s_add_u32 s52, s52, s53
    s_lshl_b32 s53, s55, 5
    s_add_u32 s52, s52, s53
    s_add_u32 s53, s52, 0x4000
    s_movk_i32 s57, 0x800
    s_cmp_eq_u32 s6, 1
    s_cselect_b32 s56, 0xffffd000, s57
    s_add_u32 s7, s3, s56
    s_cmp_eq_u32 s6, 2
    s_cselect_b32 s56, 0xffffd000, s57
    s_add_u32 s48, s7, s56
    s_cmp_eq_u32 s6, 3
    s_cselect_b32 s56, 0xffffd000, s57
    s_add_u32 s99, s48, s56
    s_cmp_eq_u32 s6, 4
    s_cselect_b32 s56, 0xffffd000, s57
    s_add_u32 s100, s99, s56
    s_cmp_eq_u32 s6, 5
    s_cselect_b32 s56, 0xffffd000, s57
    s_add_u32 s54, s100, s56
    s_cmp_eq_u32 s6, 6
    s_cselect_b32 s56, 0xffffd000, s57
    s_add_u32 s55, s54, s56
    v_lshrrev_b32 v3, 3, v2
    v_bfe_u32 v4, v2, 1, 2
    v_lshrrev_b32 v5, 4, v2
    v_xor_b32 v4, v4, v5
    v_lshlrev_b32 v4, 5, v4
    v_and_b32 v5, 1, v2
    v_lshl_add_u32 v4, v5, 4, v4
    v_lshl_add_u32 v13, v3, 10, v4
    v_lshlrev_b32 v14, 4, v2
    v_lshrrev_b32 v3, 2, v2
    v_lshlrev_b32 v3, 7, v3
    v_and_b32 v4, 3, v2
    v_lshl_add_u32 v3, v4, 3, v3
    v_lshrrev_b32 v8, 1, v1
    v_lshl_add_u32 v3, v8, 11, v3
    v_bfe_u32 v9, v2, 3, 2
    v_xor_b32 v9, v9, v8
    v_xor_b32 v8, 0, v9
    v_lshl_add_u32 v4, v8, 5, v3
    v_xor_b32 v8, 1, v9
    v_lshl_add_u32 v5, v8, 5, v3
    v_xor_b32 v8, 2, v9
    v_lshl_add_u32 v6, v8, 5, v3
    v_xor_b32 v8, 3, v9
    v_lshl_add_u32 v7, v8, 5, v3
    v_min_u32 v15, 7, v2
    v_lshlrev_b32 v15, 2, v15
    v_mov_b32 v18, 1
    v_mov_b32 v19, 0
    s_mov_b32 s47, 0xffff0000
    v_mov_b32 v64, -1
    v_mov_b32 v65, -1
    v_mov_b32 v66, -1
    v_mov_b32 v67, -1
    v_and_b32 v3, 32, v2
    v_add_u32 v3, v3, v2
    v_lshlrev_b32 v3, 4, v3
    v_lshlrev_b32 v68, 6, v0
    s_waitcnt vmcnt(4)
    s_barrier
    ds_read_b64_tr_b16 v[96:97], v20 offset:16384
    ds_read_b64_tr_b16 v[98:99], v20 offset:16896
    ds_read_b128 v[128:131], v26 offset:0
    ds_read_b128 v[132:135], v26 offset:2048
    ds_read_b64_tr_b16 v[100:101], v20 offset:24576
    ds_read_b64_tr_b16 v[102:103], v20 offset:25088
    ds_read_b64_tr_b16 v[104:105], v21 offset:16384
    ds_read_b64_tr_b16 v[106:107], v21 offset:16896
    ds_read_b64_tr_b16 v[108:109], v21 offset:24576
    ds_read_b64_tr_b16 v[110:111], v21 offset:25088
    s_waitcnt lgkmcnt(7)
    v_mfma_f32_16x16x32_bf16 v[32:35], v[96:99], v[128:131], 0
    ds_read_b64_tr_b16 v[112:113], v20 offset:20480
    ds_read_b64_tr_b16 v[114:115], v20 offset:20992
    s_add_u32 m0, s42, 65536
    s_nop 0
    buffer_load_dwordx4 v10, s[8:11], s40 offen lds
    s_waitcnt lgkmcnt(8)
    v_mfma_f32_16x16x32_bf16 v[40:43], v[96:99], v[132:135], 0
    ds_read_b128 v[136:139], v27 offset:0
    ds_read_b128 v[140:143], v27 offset:2048
    s_add_u32 m0, s42, 81920
    s_nop 0
    buffer_load_dwordx4 v12, s[12:15], s41 offen lds
    s_waitcnt lgkmcnt(8)
    v_mfma_f32_16x16x32_bf16 v[36:39], v[100:103], v[128:131], 0
    ds_read_b64_tr_b16 v[116:117], v20 offset:28672
    ds_read_b64_tr_b16 v[118:119], v20 offset:29184
    s_add_u32 m0, s42, 90112
    s_nop 0
    buffer_load_dwordx4 v12, s[16:19], s41 offen lds
    v_mfma_f32_16x16x32_bf16 v[44:47], v[100:103], v[132:135], 0
    ds_read_b64_tr_b16 v[120:121], v21 offset:20480
    ds_read_b64_tr_b16 v[122:123], v21 offset:20992
    s_add_u32 m0, s42, 73728
    s_nop 0
    buffer_load_dwordx4 v11, s[8:11], s40 offen lds
    s_add_u32 s44, s44, 1
    s_and_b32 s44, s44, 7
    s_lshl_b32 s40, s44, 7
    s_add_u32 s40, s40, s4
    s_mul_i32 s41, s44, 229376
    s_add_u32 s41, s41, s5
    s_waitcnt lgkmcnt(10)
    v_mfma_f32_16x16x32_bf16 v[48:51], v[104:107], v[128:131], 0
    ds_read_b64_tr_b16 v[124:125], v21 offset:28672
    ds_read_b64_tr_b16 v[126:127], v21 offset:29184
    s_add_u32 m0, s42, 98304
    s_nop 0
    buffer_load_dwordx4 v10, s[8:11], s40 offen lds
    v_mfma_f32_16x16x32_bf16 v[56:59], v[104:107], v[132:135], 0
    s_add_u32 m0, s42, 114688
    s_nop 0
    buffer_load_dwordx4 v12, s[12:15], s41 offen lds
    s_waitcnt lgkmcnt(10)
    v_mfma_f32_16x16x32_bf16 v[52:55], v[108:111], v[128:131], 0
    s_add_u32 m0, s42, 122880
    s_nop 0
    buffer_load_dwordx4 v12, s[16:19], s41 offen lds
    v_mfma_f32_16x16x32_bf16 v[60:63], v[108:111], v[132:135], 0
    s_add_u32 m0, s42, 106496
    s_nop 0
    buffer_load_dwordx4 v11, s[8:11], s40 offen lds
    s_add_u32 s44, s44, 1
    s_and_b32 s44, s44, 7
    s_lshl_b32 s40, s44, 7
    s_add_u32 s40, s40, s4
    s_mul_i32 s41, s44, 229376
    s_add_u32 s41, s41, s5
    s_waitcnt lgkmcnt(7)
    v_mfma_f32_16x16x32_bf16 v[32:35], v[112:115], v[136:139], v[32:35]
    s_add_u32 m0, s42, 131072
    s_nop 0
    buffer_load_dwordx4 v10, s[8:11], s40 offen lds
    s_waitcnt lgkmcnt(6)
    v_mfma_f32_16x16x32_bf16 v[40:43], v[112:115], v[140:143], v[40:43]
    s_add_u32 m0, s42, 147456
    s_nop 0
    buffer_load_dwordx4 v12, s[12:15], s41 offen lds
    s_waitcnt vmcnt(10) lgkmcnt(0)
    s_barrier
    v_mfma_f32_16x16x32_bf16 v[36:39], v[116:119], v[136:139], v[36:39]
    ds_read_b64_tr_b16 v[96:97], v20 offset:49152
    ds_read_b64_tr_b16 v[98:99], v20 offset:49664
    s_add_u32 m0, s42, 155648
    s_nop 0
    buffer_load_dwordx4 v12, s[16:19], s41 offen lds
    v_mfma_f32_16x16x32_bf16 v[44:47], v[116:119], v[140:143], v[44:47]
    ds_read_b128 v[144:147], v26 offset:32768
    ds_read_b128 v[148:151], v26 offset:34816
    v_mfma_f32_16x16x32_bf16 v[48:51], v[120:123], v[136:139], v[48:51]
    ds_read_b64_tr_b16 v[100:101], v20 offset:57344
    ds_read_b64_tr_b16 v[102:103], v20 offset:57856
    s_add_u32 m0, s42, 139264
    s_nop 0
    buffer_load_dwordx4 v11, s[8:11], s40 offen lds
    s_add_u32 s44, s44, 1
    s_and_b32 s44, s44, 7
    s_lshl_b32 s40, s44, 7
    s_add_u32 s40, s40, s4
    s_mul_i32 s41, s44, 229376
    s_add_u32 s41, s41, s5
    v_mfma_f32_16x16x32_bf16 v[56:59], v[120:123], v[140:143], v[56:59]
    ds_read_b64_tr_b16 v[104:105], v21 offset:49152
    ds_read_b64_tr_b16 v[106:107], v21 offset:49664
    v_mfma_f32_16x16x32_bf16 v[52:55], v[124:127], v[136:139], v[52:55]
    ds_read_b64_tr_b16 v[108:109], v21 offset:57344
    ds_read_b64_tr_b16 v[110:111], v21 offset:57856
    s_add_u32 m0, s42, 0
    s_nop 0
    buffer_load_dwordx4 v10, s[8:11], s40 offen lds
    v_mfma_f32_16x16x32_bf16 v[60:63], v[124:127], v[140:143], v[60:63]
    s_waitcnt lgkmcnt(7)
    v_mfma_f32_16x16x32_bf16 v[32:35], v[96:99], v[144:147], v[32:35]
    ds_read_b64_tr_b16 v[112:113], v20 offset:53248
    ds_read_b64_tr_b16 v[114:115], v20 offset:53760
    s_add_u32 m0, s42, 16384
    s_nop 0
    buffer_load_dwordx4 v12, s[12:15], s41 offen lds
    s_waitcnt lgkmcnt(8)
    v_mfma_f32_16x16x32_bf16 v[40:43], v[96:99], v[148:151], v[40:43]
    ds_read_b128 v[152:155], v27 offset:32768
    ds_read_b128 v[156:159], v27 offset:34816
    s_waitcnt lgkmcnt(8)
    v_mfma_f32_16x16x32_bf16 v[36:39], v[100:103], v[144:147], v[36:39]
    ds_read_b64_tr_b16 v[116:117], v20 offset:61440
    ds_read_b64_tr_b16 v[118:119], v20 offset:61952
    s_add_u32 m0, s42, 24576
    s_nop 0
    buffer_load_dwordx4 v12, s[16:19], s41 offen lds
    v_mfma_f32_16x16x32_bf16 v[44:47], v[100:103], v[148:151], v[44:47]
    ds_read_b64_tr_b16 v[120:121], v21 offset:53248
    ds_read_b64_tr_b16 v[122:123], v21 offset:53760
    s_waitcnt lgkmcnt(10)
    v_mfma_f32_16x16x32_bf16 v[48:51], v[104:107], v[144:147], v[48:51]
    ds_read_b64_tr_b16 v[124:125], v21 offset:61440
    ds_read_b64_tr_b16 v[126:127], v21 offset:61952
    s_add_u32 m0, s42, 8192
    s_nop 0
    buffer_load_dwordx4 v11, s[8:11], s40 offen lds
    s_add_u32 s44, s44, 1
    s_and_b32 s44, s44, 7
    s_lshl_b32 s40, s44, 7
    s_add_u32 s40, s40, s4
    s_mul_i32 s41, s44, 229376
    s_add_u32 s41, s41, s5
    v_mfma_f32_16x16x32_bf16 v[56:59], v[104:107], v[148:151], v[56:59]
    s_waitcnt lgkmcnt(10)
    v_mfma_f32_16x16x32_bf16 v[52:55], v[108:111], v[144:147], v[52:55]
    v_mfma_f32_16x16x32_bf16 v[60:63], v[108:111], v[148:151], v[60:63]
    s_waitcnt lgkmcnt(7)
    v_mfma_f32_16x16x32_bf16 v[32:35], v[112:115], v[152:155], v[32:35]
    s_waitcnt lgkmcnt(6)
    v_mfma_f32_16x16x32_bf16 v[40:43], v[112:115], v[156:159], v[40:43]
    s_waitcnt vmcnt(12) lgkmcnt(0)
    s_barrier
    v_mfma_f32_16x16x32_bf16 v[36:39], v[116:119], v[152:155], v[36:39]
    ds_read_b64_tr_b16 v[96:97], v22 offset:16384
    ds_read_b64_tr_b16 v[98:99], v22 offset:16896
    s_add_u32 m0, s42, 32768
    s_nop 0
    buffer_load_dwordx4 v10, s[8:11], s40 offen lds
    v_mfma_f32_16x16x32_bf16 v[44:47], v[116:119], v[156:159], v[44:47]
    ds_read_b128 v[160:163], v28 offset:0
    ds_read_b128 v[164:167], v28 offset:2048
    v_mfma_f32_16x16x32_bf16 v[48:51], v[120:123], v[152:155], v[48:51]
    ds_read_b64_tr_b16 v[100:101], v22 offset:24576
    ds_read_b64_tr_b16 v[102:103], v22 offset:25088
    v_mfma_f32_16x16x32_bf16 v[56:59], v[120:123], v[156:159], v[56:59]
    ds_read_b64_tr_b16 v[104:105], v23 offset:16384
    ds_read_b64_tr_b16 v[106:107], v23 offset:16896
    s_add_u32 m0, s42, 49152
    s_nop 0
    buffer_load_dwordx4 v12, s[12:15], s41 offen lds
    v_mfma_f32_16x16x32_bf16 v[52:55], v[124:127], v[152:155], v[52:55]
    ds_read_b64_tr_b16 v[108:109], v23 offset:24576
    ds_read_b64_tr_b16 v[110:111], v23 offset:25088
    v_mfma_f32_16x16x32_bf16 v[60:63], v[124:127], v[156:159], v[60:63]
    s_waitcnt lgkmcnt(7)
    v_mfma_f32_16x16x32_bf16 v[32:35], v[96:99], v[160:163], v[32:35]
    ds_read_b64_tr_b16 v[112:113], v22 offset:20480
    ds_read_b64_tr_b16 v[114:115], v22 offset:20992
    s_add_u32 m0, s42, 57344
    s_nop 0
    buffer_load_dwordx4 v12, s[16:19], s41 offen lds
    s_waitcnt lgkmcnt(8)
    v_mfma_f32_16x16x32_bf16 v[40:43], v[96:99], v[164:167], v[40:43]
    ds_read_b128 v[168:171], v29 offset:0
    ds_read_b128 v[172:175], v29 offset:2048
    s_waitcnt lgkmcnt(8)
    v_mfma_f32_16x16x32_bf16 v[36:39], v[100:103], v[160:163], v[36:39]
    ds_read_b64_tr_b16 v[116:117], v22 offset:28672
    ds_read_b64_tr_b16 v[118:119], v22 offset:29184
    v_mfma_f32_16x16x32_bf16 v[44:47], v[100:103], v[164:167], v[44:47]
    ds_read_b64_tr_b16 v[120:121], v23 offset:20480
    ds_read_b64_tr_b16 v[122:123], v23 offset:20992
    s_add_u32 m0, s42, 40960
    s_nop 0
    buffer_load_dwordx4 v11, s[8:11], s40 offen lds
    s_add_u32 s44, s44, 1
    s_and_b32 s44, s44, 7
    s_lshl_b32 s40, s44, 7
    s_add_u32 s40, s40, s4
    s_mul_i32 s41, s44, 229376
    s_add_u32 s41, s41, s5
    s_waitcnt lgkmcnt(10)
    v_mfma_f32_16x16x32_bf16 v[48:51], v[104:107], v[160:163], v[48:51]
    ds_read_b64_tr_b16 v[124:125], v23 offset:28672
    ds_read_b64_tr_b16 v[126:127], v23 offset:29184
    v_mfma_f32_16x16x32_bf16 v[56:59], v[104:107], v[164:167], v[56:59]
    s_waitcnt lgkmcnt(10)
    v_mfma_f32_16x16x32_bf16 v[52:55], v[108:111], v[160:163], v[52:55]
    v_mfma_f32_16x16x32_bf16 v[60:63], v[108:111], v[164:167], v[60:63]
    s_waitcnt lgkmcnt(7)
    v_mfma_f32_16x16x32_bf16 v[32:35], v[112:115], v[168:171], v[32:35]
    s_waitcnt lgkmcnt(6)
    v_mfma_f32_16x16x32_bf16 v[40:43], v[112:115], v[172:175], v[40:43]
    s_waitcnt vmcnt(12) lgkmcnt(0)
    s_barrier
    v_mfma_f32_16x16x32_bf16 v[36:39], v[116:119], v[168:171], v[36:39]
    ds_read_b64_tr_b16 v[96:97], v22 offset:49152
    ds_read_b64_tr_b16 v[98:99], v22 offset:49664
    s_add_u32 m0, s42, 65536
    s_nop 0
    buffer_load_dwordx4 v10, s[8:11], s40 offen lds
    v_mfma_f32_16x16x32_bf16 v[44:47], v[116:119], v[172:175], v[44:47]
    ds_read_b128 v[176:179], v28 offset:32768
    ds_read_b128 v[180:183], v28 offset:34816
    v_mfma_f32_16x16x32_bf16 v[48:51], v[120:123], v[168:171], v[48:51]
    ds_read_b64_tr_b16 v[100:101], v22 offset:57344
    ds_read_b64_tr_b16 v[102:103], v22 offset:57856
    v_mfma_f32_16x16x32_bf16 v[56:59], v[120:123], v[172:175], v[56:59]
    ds_read_b64_tr_b16 v[104:105], v23 offset:49152
    ds_read_b64_tr_b16 v[106:107], v23 offset:49664
    s_add_u32 m0, s42, 81920
    s_nop 0
    buffer_load_dwordx4 v12, s[12:15], s41 offen lds
    v_mfma_f32_16x16x32_bf16 v[52:55], v[124:127], v[168:171], v[52:55]
    ds_read_b64_tr_b16 v[108:109], v23 offset:57344
    ds_read_b64_tr_b16 v[110:111], v23 offset:57856
    v_mfma_f32_16x16x32_bf16 v[60:63], v[124:127], v[172:175], v[60:63]
    s_waitcnt lgkmcnt(7)
    v_mfma_f32_16x16x32_bf16 v[32:35], v[96:99], v[176:179], v[32:35]
    ds_read_b64_tr_b16 v[112:113], v22 offset:53248
    ds_read_b64_tr_b16 v[114:115], v22 offset:53760
    s_add_u32 m0, s42, 90112
    s_nop 0
    buffer_load_dwordx4 v12, s[16:19], s41 offen lds
    s_waitcnt lgkmcnt(8)
    v_mfma_f32_16x16x32_bf16 v[40:43], v[96:99], v[180:183], v[40:43]
    ds_read_b128 v[184:187], v29 offset:32768
    ds_read_b128 v[188:191], v29 offset:34816
    s_waitcnt lgkmcnt(8)
    v_mfma_f32_16x16x32_bf16 v[36:39], v[100:103], v[176:179], v[36:39]
    ds_read_b64_tr_b16 v[116:117], v22 offset:61440
    ds_read_b64_tr_b16 v[118:119], v22 offset:61952
    v_mfma_f32_16x16x32_bf16 v[44:47], v[100:103], v[180:183], v[44:47]
    ds_read_b64_tr_b16 v[120:121], v23 offset:53248
    ds_read_b64_tr_b16 v[122:123], v23 offset:53760
    s_add_u32 m0, s42, 73728
    s_nop 0
    buffer_load_dwordx4 v11, s[8:11], s40 offen lds
    s_add_u32 s44, s44, 1
    s_and_b32 s44, s44, 7
    s_add_u32 s5, s5, 1792
    s_mul_i32 s41, s44, 229376
    s_add_u32 s41, s41, s5
    s_waitcnt lgkmcnt(10)
    v_mfma_f32_16x16x32_bf16 v[48:51], v[104:107], v[176:179], v[48:51]
    ds_read_b64_tr_b16 v[124:125], v23 offset:61440
    ds_read_b64_tr_b16 v[126:127], v23 offset:61952
    v_mfma_f32_16x16x32_bf16 v[56:59], v[104:107], v[180:183], v[56:59]
    s_waitcnt lgkmcnt(10)
    v_mfma_f32_16x16x32_bf16 v[52:55], v[108:111], v[176:179], v[52:55]
    v_mfma_f32_16x16x32_bf16 v[60:63], v[108:111], v[180:183], v[60:63]
    s_waitcnt lgkmcnt(7)
    v_mfma_f32_16x16x32_bf16 v[32:35], v[112:115], v[184:187], v[32:35]
    s_waitcnt lgkmcnt(6)
    v_mfma_f32_16x16x32_bf16 v[40:43], v[112:115], v[188:191], v[40:43]
    s_waitcnt vmcnt(12) lgkmcnt(0)
    s_barrier
    v_mfma_f32_16x16x32_bf16 v[36:39], v[116:119], v[184:187], v[36:39]
    ds_read_b64_tr_b16 v[96:97], v24 offset:16384
    ds_read_b64_tr_b16 v[98:99], v24 offset:16896
    s_add_u32 m0, s42, 98304
    s_nop 0
    buffer_load_dwordx4 v12, s[12:15], s41 offen lds
    v_mfma_f32_16x16x32_bf16 v[44:47], v[116:119], v[188:191], v[44:47]
    ds_read_b128 v[192:195], v30 offset:0
    ds_read_b128 v[196:199], v30 offset:2048
    v_mfma_f32_16x16x32_bf16 v[48:51], v[120:123], v[184:187], v[48:51]
    ds_read_b64_tr_b16 v[100:101], v24 offset:24576
    ds_read_b64_tr_b16 v[102:103], v24 offset:25088
    v_mfma_f32_16x16x32_bf16 v[56:59], v[120:123], v[188:191], v[56:59]
    ds_read_b64_tr_b16 v[104:105], v25 offset:16384
    ds_read_b64_tr_b16 v[106:107], v25 offset:16896
    s_add_u32 m0, s42, 106496
    s_nop 0
    buffer_load_dwordx4 v12, s[16:19], s41 offen lds
    s_add_u32 s44, s44, 1
    s_and_b32 s44, s44, 7
    s_mul_i32 s41, s44, 229376
    s_add_u32 s41, s41, s5
    v_mfma_f32_16x16x32_bf16 v[52:55], v[124:127], v[184:187], v[52:55]
    ds_read_b64_tr_b16 v[108:109], v25 offset:24576
    ds_read_b64_tr_b16 v[110:111], v25 offset:25088
    v_mfma_f32_16x16x32_bf16 v[60:63], v[124:127], v[188:191], v[60:63]
    s_waitcnt lgkmcnt(7)
    v_mfma_f32_16x16x32_bf16 v[32:35], v[96:99], v[192:195], v[32:35]
    ds_read_b64_tr_b16 v[112:113], v24 offset:20480
    ds_read_b64_tr_b16 v[114:115], v24 offset:20992
    buffer_store_dwordx4 v[64:67], v3, s[28:31], s46 offen offset:0 sc1
    s_waitcnt lgkmcnt(8)
    v_mfma_f32_16x16x32_bf16 v[40:43], v[96:99], v[196:199], v[40:43]
    ds_read_b128 v[200:203], v31 offset:0
    ds_read_b128 v[204:207], v31 offset:2048
    s_waitcnt lgkmcnt(8)
    v_mfma_f32_16x16x32_bf16 v[36:39], v[100:103], v[192:195], v[36:39]
    ds_read_b64_tr_b16 v[116:117], v24 offset:28672
    ds_read_b64_tr_b16 v[118:119], v24 offset:29184
    v_mfma_f32_16x16x32_bf16 v[44:47], v[100:103], v[196:199], v[44:47]
    ds_read_b64_tr_b16 v[120:121], v25 offset:20480
    ds_read_b64_tr_b16 v[122:123], v25 offset:20992
    s_add_u32 m0, s42, 114688
    s_nop 0
    buffer_load_dwordx4 v12, s[12:15], s41 offen lds
    s_waitcnt lgkmcnt(10)
    v_mfma_f32_16x16x32_bf16 v[48:51], v[104:107], v[192:195], v[48:51]
    ds_read_b64_tr_b16 v[124:125], v25 offset:28672
    ds_read_b64_tr_b16 v[126:127], v25 offset:29184
    v_mfma_f32_16x16x32_bf16 v[56:59], v[104:107], v[196:199], v[56:59]
    s_waitcnt lgkmcnt(10)
    v_mfma_f32_16x16x32_bf16 v[52:55], v[108:111], v[192:195], v[52:55]
    s_add_u32 m0, s42, 122880
    s_nop 0
    buffer_load_dwordx4 v12, s[16:19], s41 offen lds
    s_add_u32 s44, s44, 1
    s_and_b32 s44, s44, 7
    s_mul_i32 s41, s44, 229376
    s_add_u32 s41, s41, s5
    v_mfma_f32_16x16x32_bf16 v[60:63], v[108:111], v[196:199], v[60:63]
    s_waitcnt lgkmcnt(7)
    v_mfma_f32_16x16x32_bf16 v[32:35], v[112:115], v[200:203], v[32:35]
    s_waitcnt lgkmcnt(6)
    v_mfma_f32_16x16x32_bf16 v[40:43], v[112:115], v[204:207], v[40:43]
    global_load_dword v17, v19, s[32:33]
    s_waitcnt vmcnt(14) lgkmcnt(0)
    s_barrier
    v_mfma_f32_16x16x32_bf16 v[36:39], v[116:119], v[200:203], v[36:39]
    ds_read_b64_tr_b16 v[96:97], v20 offset:16384
    ds_read_b64_tr_b16 v[98:99], v20 offset:16896
    s_add_u32 m0, s42, 131072
    s_nop 0
    buffer_load_dwordx4 v12, s[12:15], s41 offen lds
    v_mfma_f32_16x16x32_bf16 v[44:47], v[116:119], v[204:207], v[44:47]
    ds_read_b128 v[208:211], v26 offset:0
    ds_read_b128 v[212:215], v26 offset:2048
    v_mfma_f32_16x16x32_bf16 v[48:51], v[120:123], v[200:203], v[48:51]
    ds_read_b64_tr_b16 v[100:101], v20 offset:24576
    ds_read_b64_tr_b16 v[102:103], v20 offset:25088
    v_mfma_f32_16x16x32_bf16 v[56:59], v[120:123], v[204:207], v[56:59]
    ds_read_b64_tr_b16 v[104:105], v21 offset:16384
    ds_read_b64_tr_b16 v[106:107], v21 offset:16896
    s_add_u32 m0, s42, 139264
    s_nop 0
    buffer_load_dwordx4 v12, s[16:19], s41 offen lds
    s_add_u32 s44, s44, 1
    s_and_b32 s44, s44, 7
    s_mul_i32 s41, s44, 229376
    s_add_u32 s41, s41, s5
    v_mfma_f32_16x16x32_bf16 v[52:55], v[124:127], v[200:203], v[52:55]
    ds_read_b64_tr_b16 v[108:109], v21 offset:24576
    ds_read_b64_tr_b16 v[110:111], v21 offset:25088
    v_mfma_f32_16x16x32_bf16 v[60:63], v[124:127], v[204:207], v[60:63]
    s_waitcnt lgkmcnt(7)
    v_mfma_f32_16x16x32_bf16 v[32:35], v[96:99], v[208:211], v[32:35]
    ds_read_b64_tr_b16 v[112:113], v20 offset:20480
    ds_read_b64_tr_b16 v[114:115], v20 offset:20992
    s_add_u32 m0, s42, 147456
    s_nop 0
    buffer_load_dwordx4 v12, s[12:15], s41 offen lds
    s_waitcnt lgkmcnt(8)
    v_mfma_f32_16x16x32_bf16 v[40:43], v[96:99], v[212:215], v[40:43]
    ds_read_b128 v[216:219], v27 offset:0
    ds_read_b128 v[220:223], v27 offset:2048
    s_waitcnt lgkmcnt(8)
    v_mfma_f32_16x16x32_bf16 v[36:39], v[100:103], v[208:211], v[36:39]
    ds_read_b64_tr_b16 v[116:117], v20 offset:28672
    ds_read_b64_tr_b16 v[118:119], v20 offset:29184
    v_mfma_f32_16x16x32_bf16 v[44:47], v[100:103], v[212:215], v[44:47]
    ds_read_b64_tr_b16 v[120:121], v21 offset:20480
    ds_read_b64_tr_b16 v[122:123], v21 offset:20992
    s_add_u32 m0, s42, 155648
    s_nop 0
    buffer_load_dwordx4 v12, s[16:19], s41 offen lds
    s_add_u32 s44, s44, 1
    s_and_b32 s44, s44, 7
    s_mul_i32 s41, s44, 229376
    s_add_u32 s41, s41, s5
    s_waitcnt lgkmcnt(10)
    v_mfma_f32_16x16x32_bf16 v[48:51], v[104:107], v[208:211], v[48:51]
    ds_read_b64_tr_b16 v[124:125], v21 offset:28672
    ds_read_b64_tr_b16 v[126:127], v21 offset:29184
    v_mfma_f32_16x16x32_bf16 v[56:59], v[104:107], v[212:215], v[56:59]
    s_waitcnt lgkmcnt(10)
    v_mfma_f32_16x16x32_bf16 v[52:55], v[108:111], v[208:211], v[52:55]
    buffer_store_dwordx4 v[64:67], v3, s[28:31], s46 offen offset:2048 sc1
    v_mfma_f32_16x16x32_bf16 v[60:63], v[108:111], v[212:215], v[60:63]
    s_waitcnt lgkmcnt(7)
    v_mfma_f32_16x16x32_bf16 v[32:35], v[112:115], v[216:219], v[32:35]
    s_waitcnt lgkmcnt(6)
    v_mfma_f32_16x16x32_bf16 v[40:43], v[112:115], v[220:223], v[40:43]
    s_waitcnt vmcnt(15) lgkmcnt(0)
    s_barrier
    v_mfma_f32_16x16x32_bf16 v[36:39], v[116:119], v[216:219], v[36:39]
    ds_read_b64_tr_b16 v[96:97], v20 offset:49152
    ds_read_b64_tr_b16 v[98:99], v20 offset:49664
    s_add_u32 m0, s42, 0
    s_nop 0
    buffer_load_dwordx4 v12, s[12:15], s41 offen lds
    v_mfma_f32_16x16x32_bf16 v[44:47], v[116:119], v[220:223], v[44:47]
    ds_read_b128 v[224:227], v26 offset:32768
    ds_read_b128 v[228:231], v26 offset:34816
    v_mfma_f32_16x16x32_bf16 v[48:51], v[120:123], v[216:219], v[48:51]
    ds_read_b64_tr_b16 v[100:101], v20 offset:57344
    ds_read_b64_tr_b16 v[102:103], v20 offset:57856
    v_mfma_f32_16x16x32_bf16 v[56:59], v[120:123], v[220:223], v[56:59]
    ds_read_b64_tr_b16 v[104:105], v21 offset:49152
    ds_read_b64_tr_b16 v[106:107], v21 offset:49664
    s_add_u32 m0, s42, 8192
    s_nop 0
    buffer_load_dwordx4 v12, s[16:19], s41 offen lds
    s_add_u32 s44, s44, 1
    s_and_b32 s44, s44, 7
    s_mul_i32 s41, s44, 229376
    s_add_u32 s41, s41, s5
    v_mfma_f32_16x16x32_bf16 v[52:55], v[124:127], v[216:219], v[52:55]
    ds_read_b64_tr_b16 v[108:109], v21 offset:57344
    ds_read_b64_tr_b16 v[110:111], v21 offset:57856
    v_mfma_f32_16x16x32_bf16 v[60:63], v[124:127], v[220:223], v[60:63]
    s_waitcnt lgkmcnt(7)
    v_mfma_f32_16x16x32_bf16 v[32:35], v[96:99], v[224:227], v[32:35]
    ds_read_b64_tr_b16 v[112:113], v20 offset:53248
    ds_read_b64_tr_b16 v[114:115], v20 offset:53760
    s_add_u32 m0, s42, 16384
    s_nop 0
    buffer_load_dwordx4 v12, s[12:15], s41 offen lds
    s_waitcnt lgkmcnt(8)
    v_mfma_f32_16x16x32_bf16 v[40:43], v[96:99], v[228:231], v[40:43]
    ds_read_b128 v[232:235], v27 offset:32768
    ds_read_b128 v[236:239], v27 offset:34816
    s_waitcnt lgkmcnt(8)
    v_mfma_f32_16x16x32_bf16 v[36:39], v[100:103], v[224:227], v[36:39]
    ds_read_b64_tr_b16 v[116:117], v20 offset:61440
    ds_read_b64_tr_b16 v[118:119], v20 offset:61952
    v_mfma_f32_16x16x32_bf16 v[44:47], v[100:103], v[228:231], v[44:47]
    ds_read_b64_tr_b16 v[120:121], v21 offset:53248
    ds_read_b64_tr_b16 v[122:123], v21 offset:53760
    s_add_u32 m0, s42, 24576
    s_nop 0
    buffer_load_dwordx4 v12, s[16:19], s41 offen lds
    s_add_u32 s44, s44, 1
    s_and_b32 s44, s44, 7
    s_mul_i32 s41, s44, 229376
    s_add_u32 s41, s41, s5
    s_waitcnt lgkmcnt(10)
    v_mfma_f32_16x16x32_bf16 v[48:51], v[104:107], v[224:227], v[48:51]
    ds_read_b64_tr_b16 v[124:125], v21 offset:61440
    ds_read_b64_tr_b16 v[126:127], v21 offset:61952
    v_mfma_f32_16x16x32_bf16 v[56:59], v[104:107], v[228:231], v[56:59]
    s_waitcnt lgkmcnt(10)
    v_mfma_f32_16x16x32_bf16 v[52:55], v[108:111], v[224:227], v[52:55]
    v_mfma_f32_16x16x32_bf16 v[60:63], v[108:111], v[228:231], v[60:63]
    s_waitcnt lgkmcnt(7)
    v_mfma_f32_16x16x32_bf16 v[32:35], v[112:115], v[232:235], v[32:35]
    s_waitcnt lgkmcnt(6)
    v_mfma_f32_16x16x32_bf16 v[40:43], v[112:115], v[236:239], v[40:43]
    s_waitcnt vmcnt(15) lgkmcnt(0)
    s_barrier
    v_mfma_f32_16x16x32_bf16 v[36:39], v[116:119], v[232:235], v[36:39]
    ds_read_b64_tr_b16 v[96:97], v22 offset:16384
    ds_read_b64_tr_b16 v[98:99], v22 offset:16896
    s_add_u32 m0, s42, 32768
    s_nop 0
    buffer_load_dwordx4 v13, s[20:23], s43 offen lds
    s_add_u32 s43, s43, 0x2000
    v_mfma_f32_16x16x32_bf16 v[44:47], v[116:119], v[236:239], v[44:47]
    ds_read_b128 v[240:243], v28 offset:0
    ds_read_b128 v[244:247], v28 offset:2048
    v_mfma_f32_16x16x32_bf16 v[48:51], v[120:123], v[232:235], v[48:51]
    ds_read_b64_tr_b16 v[100:101], v22 offset:24576
    ds_read_b64_tr_b16 v[102:103], v22 offset:25088
    v_mfma_f32_16x16x32_bf16 v[56:59], v[120:123], v[236:239], v[56:59]
    ds_read_b64_tr_b16 v[104:105], v23 offset:16384
    ds_read_b64_tr_b16 v[106:107], v23 offset:16896
    s_add_u32 m0, s42, 40960
    s_nop 0
    buffer_load_dwordx4 v13, s[20:23], s43 offen lds
    s_add_u32 s43, s43, 0x6000
    s_sub_u32 s6, s6, 1
    s_cmp_eq_u32 s6, 0
    s_cselect_b32 s56, 229376, 0
    s_cselect_b32 s6, 7, s6
    s_sub_u32 s43, s43, s56
    v_mfma_f32_16x16x32_bf16 v[52:55], v[124:127], v[232:235], v[52:55]
    ds_read_b64_tr_b16 v[108:109], v23 offset:24576
    ds_read_b64_tr_b16 v[110:111], v23 offset:25088
    v_mfma_f32_16x16x32_bf16 v[60:63], v[124:127], v[236:239], v[60:63]
    s_waitcnt lgkmcnt(7)
    v_mfma_f32_16x16x32_bf16 v[32:35], v[96:99], v[240:243], v[32:35]
    ds_read_b64_tr_b16 v[112:113], v22 offset:20480
    ds_read_b64_tr_b16 v[114:115], v22 offset:20992
    s_add_u32 m0, s42, 49152
    s_nop 0
    buffer_load_dwordx4 v13, s[20:23], s43 offen lds
    s_add_u32 s43, s43, 0x2000
    s_waitcnt lgkmcnt(8)
    v_mfma_f32_16x16x32_bf16 v[40:43], v[96:99], v[244:247], v[40:43]
    ds_read_b128 v[248:251], v29 offset:0
    ds_read_b128 v[252:255], v29 offset:2048
    s_waitcnt lgkmcnt(8)
    v_mfma_f32_16x16x32_bf16 v[36:39], v[100:103], v[240:243], v[36:39]
    ds_read_b64_tr_b16 v[116:117], v22 offset:28672
    ds_read_b64_tr_b16 v[118:119], v22 offset:29184
    v_mfma_f32_16x16x32_bf16 v[44:47], v[100:103], v[244:247], v[44:47]
    ds_read_b64_tr_b16 v[120:121], v23 offset:20480
    ds_read_b64_tr_b16 v[122:123], v23 offset:20992
    s_add_u32 m0, s42, 57344
    s_nop 0
    buffer_load_dwordx4 v13, s[20:23], s43 offen lds
    s_add_u32 s43, s43, 0x6000
    s_sub_u32 s6, s6, 1
    s_cmp_eq_u32 s6, 0
    s_cselect_b32 s56, 229376, 0
    s_cselect_b32 s6, 7, s6
    s_sub_u32 s43, s43, s56
    s_waitcnt lgkmcnt(10)
    v_mfma_f32_16x16x32_bf16 v[48:51], v[104:107], v[240:243], v[48:51]
    ds_read_b64_tr_b16 v[124:125], v23 offset:28672
    ds_read_b64_tr_b16 v[126:127], v23 offset:29184
    v_mfma_f32_16x16x32_bf16 v[56:59], v[104:107], v[244:247], v[56:59]
    s_waitcnt lgkmcnt(10)
    v_mfma_f32_16x16x32_bf16 v[52:55], v[108:111], v[240:243], v[52:55]
    v_mfma_f32_16x16x32_bf16 v[60:63], v[108:111], v[244:247], v[60:63]
    s_waitcnt lgkmcnt(7)
    v_mfma_f32_16x16x32_bf16 v[32:35], v[112:115], v[248:251], v[32:35]
    v_add_u32 v26, 0x10000, v4
    v_add_u32 v27, 0x10000, v5
    v_add_u32 v28, 0x10000, v6
    v_add_u32 v29, 0x10000, v7
    v_add_u32 v30, 0x20000, v4
    s_waitcnt lgkmcnt(6)
    v_mfma_f32_16x16x32_bf16 v[40:43], v[112:115], v[252:255], v[40:43]
    v_add_u32 v31, 0x20000, v5
    v_add_u32 v8, 0x20000, v6
    v_add_u32 v9, 0x20000, v7
    s_waitcnt vmcnt(17) lgkmcnt(0)
    s_barrier
    v_mfma_f32_16x16x32_bf16 v[36:39], v[116:119], v[248:251], v[36:39]
    ds_read_b64_tr_b16 v[96:97], v22 offset:32768
    ds_read_b64_tr_b16 v[98:99], v22 offset:33280
    s_add_u32 m0, s42, 65536
    s_nop 0
    buffer_load_dwordx4 v13, s[20:23], s43 offen lds
    s_add_u32 s43, s43, 0x2000
    v_mfma_f32_16x16x32_bf16 v[44:47], v[116:119], v[252:255], v[44:47]
    ds_read_b64_tr_b16 v[100:101], v22 offset:40960
    ds_read_b64_tr_b16 v[102:103], v22 offset:41472
    v_mfma_f32_16x16x32_bf16 v[48:51], v[120:123], v[248:251], v[48:51]
    ds_read_b64_tr_b16 v[104:105], v23 offset:32768
    ds_read_b64_tr_b16 v[106:107], v23 offset:33280
    v_mfma_f32_16x16x32_bf16 v[56:59], v[120:123], v[252:255], v[56:59]
    ds_read_b64_tr_b16 v[108:109], v23 offset:40960
    ds_read_b64_tr_b16 v[110:111], v23 offset:41472
    s_add_u32 m0, s42, 73728
    s_nop 0
    buffer_load_dwordx4 v13, s[20:23], s43 offen lds
    s_add_u32 s43, s43, 0x6000
    s_sub_u32 s6, s6, 1
    s_cmp_eq_u32 s6, 0
    s_cselect_b32 s56, 229376, 0
    s_cselect_b32 s6, 7, s6
    s_sub_u32 s43, s43, s56
    v_mfma_f32_16x16x32_bf16 v[52:55], v[124:127], v[248:251], v[52:55]
    v_mfma_f32_16x16x32_bf16 v[60:63], v[124:127], v[252:255], v[60:63]
    s_waitcnt lgkmcnt(6)
    v_mfma_f32_16x16x32_bf16 v[64:67], v[96:99], v[128:131], 0
    ds_read_b64_tr_b16 v[112:113], v22 offset:36864
    ds_read_b64_tr_b16 v[114:115], v22 offset:37376
    s_add_u32 m0, s42, 81920
    s_nop 0
    buffer_load_dwordx4 v13, s[20:23], s43 offen lds
    s_add_u32 s43, s43, 0x2000
    v_cvt_pk_bf16_f32 v32, v32, v33
    v_pk_max_i16 v32, v32, 0
    v_and_b32 v33, s47, v32
    v_lshlrev_b32 v32, 16, v32
    v_cvt_pk_bf16_f32 v34, v34, v35
    v_mfma_f32_16x16x32_bf16 v[72:75], v[96:99], v[132:135], 0
    ds_read_b64_tr_b16 v[116:117], v22 offset:45056
    ds_read_b64_tr_b16 v[118:119], v22 offset:45568
    v_pk_max_i16 v34, v34, 0
    v_and_b32 v35, s47, v34
    v_lshlrev_b32 v34, 16, v34
    v_cvt_pk_bf16_f32 v36, 0, v36
    v_cvt_pk_bf16_f32 v37, 0, v37
    s_waitcnt lgkmcnt(8)
    v_mfma_f32_16x16x32_bf16 v[68:71], v[100:103], v[128:131], 0
    ds_read_b64_tr_b16 v[120:121], v23 offset:36864
    ds_read_b64_tr_b16 v[122:123], v23 offset:37376
    v_mul_f32 v32, v32, v36
    v_mul_f32 v33, v33, v37
    v_cvt_pk_bf16_f32 v32, v32, v33
    v_cvt_pk_bf16_f32 v38, 0, v38
    v_cvt_pk_bf16_f32 v39, 0, v39
    v_mfma_f32_16x16x32_bf16 v[76:79], v[100:103], v[132:135], 0
    ds_read_b64_tr_b16 v[124:125], v23 offset:45056
    ds_read_b64_tr_b16 v[126:127], v23 offset:45568
    s_add_u32 m0, s42, 90112
    s_nop 0
    buffer_load_dwordx4 v13, s[20:23], s43 offen lds
    s_add_u32 s43, s43, 0x6000
    s_sub_u32 s6, s6, 1
    s_cmp_eq_u32 s6, 0
    s_cselect_b32 s56, 229376, 0
    s_cselect_b32 s6, 7, s6
    s_sub_u32 s43, s43, s56
    v_mul_f32 v34, v34, v38
    v_mul_f32 v35, v35, v39
    v_cvt_pk_bf16_f32 v33, v34, v35
    v_cvt_pk_bf16_f32 v40, v40, v41
    v_pk_max_i16 v40, v40, 0
    s_waitcnt lgkmcnt(10)
    v_mfma_f32_16x16x32_bf16 v[80:83], v[104:107], v[128:131], 0
    v_and_b32 v41, s47, v40
    v_lshlrev_b32 v40, 16, v40
    v_cvt_pk_bf16_f32 v42, v42, v43
    v_pk_max_i16 v42, v42, 0
    v_and_b32 v43, s47, v42
    v_mfma_f32_16x16x32_bf16 v[88:91], v[104:107], v[132:135], 0
    v_lshlrev_b32 v42, 16, v42
    v_cvt_pk_bf16_f32 v44, 0, v44
    v_cvt_pk_bf16_f32 v45, 0, v45
    v_mul_f32 v40, v40, v44
    v_mul_f32 v41, v41, v45
    s_waitcnt lgkmcnt(8)
    v_mfma_f32_16x16x32_bf16 v[84:87], v[108:111], v[128:131], 0
    v_cvt_pk_bf16_f32 v34, v40, v41
    v_cvt_pk_bf16_f32 v46, 0, v46
    v_cvt_pk_bf16_f32 v47, 0, v47
    v_mul_f32 v42, v42, v46
    v_mul_f32 v43, v43, v47
    v_mfma_f32_16x16x32_bf16 v[92:95], v[108:111], v[132:135], 0
    v_cvt_pk_bf16_f32 v35, v42, v43
    v_permlane32_swap_b32 v32, v34
    s_nop 0
    v_permlane32_swap_b32 v33, v35
    buffer_store_dwordx4 v[32:35], v3, s[28:31], s45 offen offset:0 sc1
    s_waitcnt lgkmcnt(6)
    v_mfma_f32_16x16x32_bf16 v[64:67], v[112:115], v[136:139], v[64:67]
    v_cvt_pk_bf16_f32 v48, v48, v49
    v_pk_max_i16 v48, v48, 0
    v_and_b32 v49, s47, v48
    v_lshlrev_b32 v48, 16, v48
    v_cvt_pk_bf16_f32 v50, v50, v51
    v_mfma_f32_16x16x32_bf16 v[72:75], v[112:115], v[140:143], v[72:75]
    v_pk_max_i16 v50, v50, 0
    v_and_b32 v51, s47, v50
    v_lshlrev_b32 v50, 16, v50
    v_cvt_pk_bf16_f32 v52, 0, v52
    v_cvt_pk_bf16_f32 v53, 0, v53
    s_waitcnt vmcnt(7) lgkmcnt(0)
    s_barrier
    v_mfma_f32_16x16x32_bf16 v[68:71], v[116:119], v[136:139], v[68:71]
    ds_read_b64_tr_b16 v[96:97], v22 offset:49152
    ds_read_b64_tr_b16 v[98:99], v22 offset:49664
    s_add_u32 m0, s42, 98304
    s_nop 0
    buffer_load_dwordx4 v13, s[20:23], s43 offen lds
    s_add_u32 s43, s43, 0x2000
    v_mul_f32 v48, v48, v52
    v_mul_f32 v49, v49, v53
    v_cvt_pk_bf16_f32 v48, v48, v49
    v_cvt_pk_bf16_f32 v54, 0, v54
    v_cvt_pk_bf16_f32 v55, 0, v55
    v_mfma_f32_16x16x32_bf16 v[76:79], v[116:119], v[140:143], v[76:79]
    ds_read_b64_tr_b16 v[100:101], v22 offset:57344
    ds_read_b64_tr_b16 v[102:103], v22 offset:57856
    v_mul_f32 v50, v50, v54
    v_mul_f32 v51, v51, v55
    v_cvt_pk_bf16_f32 v49, v50, v51
    v_cvt_pk_bf16_f32 v56, v56, v57
    v_pk_max_i16 v56, v56, 0
    v_mfma_f32_16x16x32_bf16 v[80:83], v[120:123], v[136:139], v[80:83]
    ds_read_b64_tr_b16 v[104:105], v23 offset:49152
    ds_read_b64_tr_b16 v[106:107], v23 offset:49664
    v_and_b32 v57, s47, v56
    v_lshlrev_b32 v56, 16, v56
    v_cvt_pk_bf16_f32 v58, v58, v59
    v_pk_max_i16 v58, v58, 0
    v_and_b32 v59, s47, v58
    v_mfma_f32_16x16x32_bf16 v[88:91], v[120:123], v[140:143], v[88:91]
    ds_read_b64_tr_b16 v[108:109], v23 offset:57344
    ds_read_b64_tr_b16 v[110:111], v23 offset:57856
    v_lshlrev_b32 v58, 16, v58
    v_cvt_pk_bf16_f32 v60, 0, v60
    v_cvt_pk_bf16_f32 v61, 0, v61
    v_mul_f32 v56, v56, v60
    v_mul_f32 v57, v57, v61
    v_mfma_f32_16x16x32_bf16 v[84:87], v[124:127], v[136:139], v[84:87]
    s_add_u32 m0, s42, 106496
    s_nop 0
    buffer_load_dwordx4 v13, s[20:23], s43 offen lds
    s_add_u32 s43, s43, 0x6000
    s_sub_u32 s6, s6, 1
    s_cmp_eq_u32 s6, 0
    s_cselect_b32 s56, 229376, 0
    s_cselect_b32 s6, 7, s6
    s_sub_u32 s43, s43, s56
    v_cvt_pk_bf16_f32 v50, v56, v57
    v_cvt_pk_bf16_f32 v62, 0, v62
    v_cvt_pk_bf16_f32 v63, 0, v63
    v_mul_f32 v58, v58, v62
    v_mul_f32 v59, v59, v63
    v_mfma_f32_16x16x32_bf16 v[92:95], v[124:127], v[140:143], v[92:95]
    v_cvt_pk_bf16_f32 v51, v58, v59
    v_permlane32_swap_b32 v48, v50
    s_nop 0
    v_permlane32_swap_b32 v49, v51
    buffer_store_dwordx4 v[48:51], v3, s[28:31], s45 offen offset:2048 sc1
    s_waitcnt lgkmcnt(6)
    v_mfma_f32_16x16x32_bf16 v[64:67], v[96:99], v[144:147], v[64:67]
    ds_read_b64_tr_b16 v[112:113], v22 offset:53248
    ds_read_b64_tr_b16 v[114:115], v22 offset:53760
    v_mfma_f32_16x16x32_bf16 v[72:75], v[96:99], v[148:151], v[72:75]
    ds_read_b64_tr_b16 v[116:117], v22 offset:61440
    ds_read_b64_tr_b16 v[118:119], v22 offset:61952
    s_waitcnt lgkmcnt(8)
    v_mfma_f32_16x16x32_bf16 v[68:71], v[100:103], v[144:147], v[68:71]
    ds_read_b64_tr_b16 v[120:121], v23 offset:53248
    ds_read_b64_tr_b16 v[122:123], v23 offset:53760
    v_mfma_f32_16x16x32_bf16 v[76:79], v[100:103], v[148:151], v[76:79]
    ds_read_b64_tr_b16 v[124:125], v23 offset:61440
    ds_read_b64_tr_b16 v[126:127], v23 offset:61952
    s_waitcnt lgkmcnt(10)
    v_mfma_f32_16x16x32_bf16 v[80:83], v[104:107], v[144:147], v[80:83]
    ds_read_b64_tr_b16 v[128:129], v4 offset:32768
    ds_read_b64_tr_b16 v[130:131], v4 offset:40960
    v_mfma_f32_16x16x32_bf16 v[88:91], v[104:107], v[148:151], v[88:91]
    ds_read_b64_tr_b16 v[132:133], v5 offset:32768
    ds_read_b64_tr_b16 v[134:135], v5 offset:40960
    s_waitcnt lgkmcnt(12)
    v_mfma_f32_16x16x32_bf16 v[84:87], v[108:111], v[144:147], v[84:87]
    ds_read_b64_tr_b16 v[136:137], v6 offset:32768
    ds_read_b64_tr_b16 v[138:139], v6 offset:40960
    v_mfma_f32_16x16x32_bf16 v[92:95], v[108:111], v[148:151], v[92:95]
    ds_read_b64_tr_b16 v[140:141], v7 offset:32768
    ds_read_b64_tr_b16 v[142:143], v7 offset:40960
    s_waitcnt lgkmcnt(14)
    v_mfma_f32_16x16x32_bf16 v[64:67], v[112:115], v[152:155], v[64:67]
    v_mfma_f32_16x16x32_bf16 v[72:75], v[112:115], v[156:159], v[72:75]
    s_waitcnt vmcnt(8) lgkmcnt(0)
    s_barrier
    v_mfma_f32_16x16x32_bf16 v[68:71], v[116:119], v[152:155], v[68:71]
    ds_read_b64_tr_b16 v[96:97], v24 offset:0
    ds_read_b64_tr_b16 v[98:99], v24 offset:512
    s_add_u32 m0, s42, 114688
    s_nop 0
    buffer_load_dwordx4 v12, s[12:15], s41 offen lds
    v_mfma_f32_16x16x32_bf16 v[76:79], v[116:119], v[156:159], v[76:79]
    ds_read_b64_tr_b16 v[100:101], v24 offset:8192
    ds_read_b64_tr_b16 v[102:103], v24 offset:8704
    v_mfma_f32_16x16x32_bf16 v[80:83], v[120:123], v[152:155], v[80:83]
    ds_read_b64_tr_b16 v[104:105], v25 offset:0
    ds_read_b64_tr_b16 v[106:107], v25 offset:512
    v_mfma_f32_16x16x32_bf16 v[88:91], v[120:123], v[156:159], v[88:91]
    ds_read_b64_tr_b16 v[108:109], v25 offset:8192
    ds_read_b64_tr_b16 v[110:111], v25 offset:8704
    s_add_u32 m0, s42, 122880
    s_nop 0
    buffer_load_dwordx4 v12, s[16:19], s41 offen lds
    s_add_u32 s44, s44, 1
    s_and_b32 s44, s44, 7
    s_mul_i32 s41, s44, 229376
    s_add_u32 s41, s41, s5
    v_mfma_f32_16x16x32_bf16 v[84:87], v[124:127], v[152:155], v[84:87]
    v_mfma_f32_16x16x32_bf16 v[92:95], v[124:127], v[156:159], v[92:95]
    s_waitcnt vmcnt(2)
    s_mov_b32 s51, 1048576
L_go_a:
    v_readfirstlane_b32 s56, v17
    s_cmp_eq_u32 s56, 1
    s_cbranch_scc1 L_go_ok_a
    global_load_dword v17, v19, s[32:33] sc1
    s_waitcnt vmcnt(0)
    s_sub_u32 s51, s51, 1
    s_cmp_lg_u32 s51, 0
    s_cbranch_scc1 L_go_a
L_go_ok_a:
    s_mov_b64 exec, 1
    buffer_store_dword v18, v19, s[28:31], s49 offen offset:0 sc1
    s_mov_b64 exec, -1
    s_waitcnt lgkmcnt(6)
    v_mfma_f32_16x16x32_bf16 v[64:67], v[96:99], v[160:163], v[64:67]
    ds_read_b64_tr_b16 v[112:113], v24 offset:4096
    ds_read_b64_tr_b16 v[114:115], v24 offset:4608
    s_add_u32 m0, s42, 32768
    s_nop 0
    buffer_load_dwordx4 v13, s[20:23], s43 offen lds
    s_add_u32 s43, s43, 0x2000
    v_mfma_f32_16x16x32_bf16 v[72:75], v[96:99], v[164:167], v[72:75]
    ds_read_b64_tr_b16 v[116:117], v24 offset:12288
    ds_read_b64_tr_b16 v[118:119], v24 offset:12800
    s_waitcnt lgkmcnt(8)
    v_mfma_f32_16x16x32_bf16 v[68:71], v[100:103], v[160:163], v[68:71]
    ds_read_b64_tr_b16 v[120:121], v25 offset:4096
    ds_read_b64_tr_b16 v[122:123], v25 offset:4608
    v_mfma_f32_16x16x32_bf16 v[76:79], v[100:103], v[164:167], v[76:79]
    ds_read_b64_tr_b16 v[124:125], v25 offset:12288
    ds_read_b64_tr_b16 v[126:127], v25 offset:12800
    s_add_u32 m0, s42, 40960
    s_nop 0
    buffer_load_dwordx4 v13, s[20:23], s43 offen lds
    s_add_u32 s43, s43, 0x6000
    s_sub_u32 s6, s6, 1
    s_cmp_eq_u32 s6, 0
    s_cselect_b32 s56, 229376, 0
    s_cselect_b32 s6, 7, s6
    s_sub_u32 s43, s43, s56
    s_waitcnt lgkmcnt(10)
    v_mfma_f32_16x16x32_bf16 v[80:83], v[104:107], v[160:163], v[80:83]
    ds_read_b64_tr_b16 v[144:145], v4 offset:49152
    ds_read_b64_tr_b16 v[146:147], v4 offset:57344
    v_mfma_f32_16x16x32_bf16 v[88:91], v[104:107], v[164:167], v[88:91]
    ds_read_b64_tr_b16 v[148:149], v5 offset:49152
    ds_read_b64_tr_b16 v[150:151], v5 offset:57344
    s_waitcnt lgkmcnt(12)
    v_mfma_f32_16x16x32_bf16 v[84:87], v[108:111], v[160:163], v[84:87]
    ds_read_b64_tr_b16 v[152:153], v6 offset:49152
    ds_read_b64_tr_b16 v[154:155], v6 offset:57344
    v_mfma_f32_16x16x32_bf16 v[92:95], v[108:111], v[164:167], v[92:95]
    ds_read_b64_tr_b16 v[156:157], v7 offset:49152
    ds_read_b64_tr_b16 v[158:159], v7 offset:57344
    s_waitcnt lgkmcnt(14)
    v_mfma_f32_16x16x32_bf16 v[64:67], v[112:115], v[168:171], v[64:67]
    v_mfma_f32_16x16x32_bf16 v[72:75], v[112:115], v[172:175], v[72:75]
    s_waitcnt lgkmcnt(0)
    s_barrier
    v_mfma_f32_16x16x32_bf16 v[68:71], v[116:119], v[168:171], v[68:71]
    ds_read_b64_tr_b16 v[96:97], v24 offset:16384
    ds_read_b64_tr_b16 v[98:99], v24 offset:16896
    s_add_u32 m0, s42, 131072
    s_nop 0
    buffer_load_dwordx4 v12, s[12:15], s41 offen lds
    v_mfma_f32_16x16x32_bf16 v[76:79], v[116:119], v[172:175], v[76:79]
    ds_read_b64_tr_b16 v[100:101], v24 offset:24576
    ds_read_b64_tr_b16 v[102:103], v24 offset:25088
    v_mfma_f32_16x16x32_bf16 v[80:83], v[120:123], v[168:171], v[80:83]
    ds_read_b64_tr_b16 v[104:105], v25 offset:16384
    ds_read_b64_tr_b16 v[106:107], v25 offset:16896
    v_mfma_f32_16x16x32_bf16 v[88:91], v[120:123], v[172:175], v[88:91]
    ds_read_b64_tr_b16 v[108:109], v25 offset:24576
    ds_read_b64_tr_b16 v[110:111], v25 offset:25088
    s_add_u32 m0, s42, 139264
    s_nop 0
    buffer_load_dwordx4 v12, s[16:19], s41 offen lds
    v_mfma_f32_16x16x32_bf16 v[84:87], v[124:127], v[168:171], v[84:87]
    ds_read_b64_tr_b16 v[32:33], v26 offset:0
    ds_read_b64_tr_b16 v[34:35], v26 offset:8192
    v_mfma_f32_16x16x32_bf16 v[92:95], v[124:127], v[172:175], v[92:95]
    ds_read_b64_tr_b16 v[36:37], v27 offset:0
    ds_read_b64_tr_b16 v[38:39], v27 offset:8192
    s_waitcnt lgkmcnt(10)
    v_mfma_f32_16x16x32_bf16 v[64:67], v[96:99], v[176:179], v[64:67]
    ds_read_b64_tr_b16 v[112:113], v24 offset:20480
    ds_read_b64_tr_b16 v[114:115], v24 offset:20992
    s_add_u32 m0, s42, 49152
    s_nop 0
    buffer_load_dwordx4 v13, s[20:23], s43 offen lds
    s_add_u32 s43, s43, 0x2000
    v_mfma_f32_16x16x32_bf16 v[72:75], v[96:99], v[180:183], v[72:75]
    ds_read_b64_tr_b16 v[116:117], v24 offset:28672
    ds_read_b64_tr_b16 v[118:119], v24 offset:29184
    s_waitcnt lgkmcnt(12)
    v_mfma_f32_16x16x32_bf16 v[68:71], v[100:103], v[176:179], v[68:71]
    ds_read_b64_tr_b16 v[120:121], v25 offset:20480
    ds_read_b64_tr_b16 v[122:123], v25 offset:20992
    v_mfma_f32_16x16x32_bf16 v[76:79], v[100:103], v[180:183], v[76:79]
    ds_read_b64_tr_b16 v[124:125], v25 offset:28672
    ds_read_b64_tr_b16 v[126:127], v25 offset:29184
    s_add_u32 m0, s42, 57344
    s_nop 0
    buffer_load_dwordx4 v13, s[20:23], s43 offen lds
    s_mov_b32 s43, s38
    s_lshl_b32 s6, s101, 15
    s_waitcnt lgkmcnt(14)
    v_mfma_f32_16x16x32_bf16 v[80:83], v[104:107], v[176:179], v[80:83]
    ds_read_b64_tr_b16 v[40:41], v28 offset:0
    ds_read_b64_tr_b16 v[42:43], v28 offset:8192
    v_mfma_f32_16x16x32_bf16 v[88:91], v[104:107], v[180:183], v[88:91]
    ds_read_b64_tr_b16 v[44:45], v29 offset:0
    ds_read_b64_tr_b16 v[46:47], v29 offset:8192
    s_waitcnt lgkmcnt(15)
    v_mfma_f32_16x16x32_bf16 v[84:87], v[108:111], v[176:179], v[84:87]
    ds_read_b64_tr_b16 v[48:49], v26 offset:16384
    ds_read_b64_tr_b16 v[50:51], v26 offset:24576
    v_mfma_f32_16x16x32_bf16 v[92:95], v[108:111], v[180:183], v[92:95]
    ds_read_b64_tr_b16 v[52:53], v27 offset:16384
    ds_read_b64_tr_b16 v[54:55], v27 offset:24576
    s_waitcnt lgkmcnt(14)
    v_mfma_f32_16x16x32_bf16 v[64:67], v[112:115], v[184:187], v[64:67]
    ds_read_b64_tr_b16 v[56:57], v28 offset:16384
    ds_read_b64_tr_b16 v[58:59], v28 offset:24576
    v_mfma_f32_16x16x32_bf16 v[72:75], v[112:115], v[188:191], v[72:75]
    ds_read_b64_tr_b16 v[60:61], v29 offset:16384
    ds_read_b64_tr_b16 v[62:63], v29 offset:24576
    s_waitcnt lgkmcnt(0)
    s_barrier
    v_mfma_f32_16x16x32_bf16 v[68:71], v[116:119], v[184:187], v[68:71]
    ds_read_b64_tr_b16 v[96:97], v20 offset:0
    ds_read_b64_tr_b16 v[98:99], v20 offset:512
    s_add_u32 m0, s42, 147456
    s_nop 0
    buffer_load_dwordx4 v13, s[20:23], s43 offen lds
    s_add_u32 s43, s43, 0x2000
    v_mfma_f32_16x16x32_bf16 v[76:79], v[116:119], v[188:191], v[76:79]
    ds_read_b64_tr_b16 v[100:101], v20 offset:8192
    ds_read_b64_tr_b16 v[102:103], v20 offset:8704
    v_mfma_f32_16x16x32_bf16 v[80:83], v[120:123], v[184:187], v[80:83]
    ds_read_b64_tr_b16 v[104:105], v21 offset:0
    ds_read_b64_tr_b16 v[106:107], v21 offset:512
    s_add_u32 m0, s42, 155648
    s_nop 0
    buffer_load_dwordx4 v13, s[20:23], s43 offen lds
    s_add_u32 s43, s43, 0xe000
    v_mfma_f32_16x16x32_bf16 v[88:91], v[120:123], v[188:191], v[88:91]
    ds_read_b64_tr_b16 v[108:109], v21 offset:8192
    ds_read_b64_tr_b16 v[110:111], v21 offset:8704
    v_mfma_f32_16x16x32_bf16 v[84:87], v[124:127], v[184:187], v[84:87]
    ds_read_b64_tr_b16 v[160:161], v26 offset:32768
    ds_read_b64_tr_b16 v[162:163], v26 offset:40960
    s_add_u32 m0, s42, 65536
    s_nop 0
    buffer_load_dwordx4 v13, s[20:23], s43 offen lds
    s_add_u32 s43, s43, 0x2000
    v_mfma_f32_16x16x32_bf16 v[92:95], v[124:127], v[188:191], v[92:95]
    ds_read_b64_tr_b16 v[164:165], v27 offset:32768
    ds_read_b64_tr_b16 v[166:167], v27 offset:40960
    s_waitcnt lgkmcnt(10)
    v_mfma_f32_16x16x32_bf16 v[64:67], v[96:99], v[192:195], v[64:67]
    ds_read_b64_tr_b16 v[112:113], v20 offset:4096
    ds_read_b64_tr_b16 v[114:115], v20 offset:4608
    s_add_u32 m0, s42, 73728
    s_nop 0
    buffer_load_dwordx4 v13, s[20:23], s43 offen lds
    s_add_u32 s43, s43, 0xe000
    v_mfma_f32_16x16x32_bf16 v[72:75], v[96:99], v[196:199], v[72:75]
    ds_read_b64_tr_b16 v[116:117], v20 offset:12288
    ds_read_b64_tr_b16 v[118:119], v20 offset:12800
    s_waitcnt lgkmcnt(12)
    v_mfma_f32_16x16x32_bf16 v[68:71], v[100:103], v[192:195], v[68:71]
    ds_read_b64_tr_b16 v[120:121], v21 offset:4096
    ds_read_b64_tr_b16 v[122:123], v21 offset:4608
    s_add_u32 m0, s42, 81920
    s_nop 0
    buffer_load_dwordx4 v13, s[20:23], s43 offen lds
    s_add_u32 s43, s43, 0x2000
    v_mfma_f32_16x16x32_bf16 v[76:79], v[100:103], v[196:199], v[76:79]
    ds_read_b64_tr_b16 v[124:125], v21 offset:12288
    ds_read_b64_tr_b16 v[126:127], v21 offset:12800
    s_waitcnt lgkmcnt(14)
    v_mfma_f32_16x16x32_bf16 v[80:83], v[104:107], v[192:195], v[80:83]
    ds_read_b64_tr_b16 v[168:169], v28 offset:32768
    ds_read_b64_tr_b16 v[170:171], v28 offset:40960
    s_add_u32 m0, s42, 90112
    s_nop 0
    buffer_load_dwordx4 v13, s[20:23], s43 offen lds
    s_add_u32 s43, s43, 0xe000
    s_sub_u32 s43, s43, s6
    v_mfma_f32_16x16x32_bf16 v[88:91], v[104:107], v[196:199], v[88:91]
    ds_read_b64_tr_b16 v[172:173], v29 offset:32768
    ds_read_b64_tr_b16 v[174:175], v29 offset:40960
    s_waitcnt lgkmcnt(15)
    v_mfma_f32_16x16x32_bf16 v[84:87], v[108:111], v[192:195], v[84:87]
    v_mfma_f32_16x16x32_bf16 v[92:95], v[108:111], v[196:199], v[92:95]
    s_waitcnt lgkmcnt(10)
    v_mfma_f32_16x16x32_bf16 v[64:67], v[112:115], v[200:203], v[64:67]
    v_mfma_f32_16x16x32_bf16 v[72:75], v[112:115], v[204:207], v[72:75]
    s_waitcnt lgkmcnt(0)
    s_barrier
    v_mfma_f32_16x16x32_bf16 v[68:71], v[116:119], v[200:203], v[68:71]
    ds_read_b64_tr_b16 v[96:97], v20 offset:16384
    ds_read_b64_tr_b16 v[98:99], v20 offset:16896
    s_add_u32 m0, s42, 0
    s_nop 0
    buffer_load_dwordx4 v13, s[20:23], s43 offen lds
    s_add_u32 s43, s43, 0x2000
    v_mfma_f32_16x16x32_bf16 v[76:79], v[116:119], v[204:207], v[76:79]
    ds_read_b64_tr_b16 v[100:101], v20 offset:24576
    ds_read_b64_tr_b16 v[102:103], v20 offset:25088
    v_mfma_f32_16x16x32_bf16 v[80:83], v[120:123], v[200:203], v[80:83]
    ds_read_b64_tr_b16 v[104:105], v21 offset:16384
    ds_read_b64_tr_b16 v[106:107], v21 offset:16896
    v_mfma_f32_16x16x32_bf16 v[88:91], v[120:123], v[204:207], v[88:91]
    ds_read_b64_tr_b16 v[108:109], v21 offset:24576
    ds_read_b64_tr_b16 v[110:111], v21 offset:25088
    s_add_u32 m0, s42, 8192
    s_nop 0
    buffer_load_dwordx4 v13, s[20:23], s43 offen lds
    s_add_u32 s43, s43, 0xfffd6000
    s_add_u32 s43, s43, s6
    v_mfma_f32_16x16x32_bf16 v[84:87], v[124:127], v[200:203], v[84:87]
    v_mfma_f32_16x16x32_bf16 v[92:95], v[124:127], v[204:207], v[92:95]
    s_mul_i32 s56, s35, 37
    s_lshr_b32 s56, s56, 8
    s_mul_i32 s57, s56, 7
    s_sub_u32 s57, s35, s57
    s_or_b32 s57, s57, s36
    s_lshl2_add_u32 s56, s34, s56
    s_lshl_b32 s56, s56, 7
    s_add_u32 s56, s56, 7348224
    s_cmp_eq_u32 s57, 0
    s_cselect_b64 exec, 1, 0
    buffer_store_dword v18, v19, s[28:31], s56 offen sc1
    s_mov_b64 exec, -1
    s_waitcnt lgkmcnt(6)
    v_mfma_f32_16x16x32_bf16 v[64:67], v[96:99], v[208:211], v[64:67]
    ds_read_b64_tr_b16 v[112:113], v20 offset:20480
    ds_read_b64_tr_b16 v[114:115], v20 offset:20992
    buffer_load_dword v16, v15, s[28:31], s50 offen offset:0 sc1
    v_mfma_f32_16x16x32_bf16 v[72:75], v[96:99], v[212:215], v[72:75]
    ds_read_b64_tr_b16 v[116:117], v20 offset:28672
    ds_read_b64_tr_b16 v[118:119], v20 offset:29184
    s_waitcnt lgkmcnt(8)
    v_mfma_f32_16x16x32_bf16 v[68:71], v[100:103], v[208:211], v[68:71]
    ds_read_b64_tr_b16 v[120:121], v21 offset:20480
    ds_read_b64_tr_b16 v[122:123], v21 offset:20992
    v_mfma_f32_16x16x32_bf16 v[76:79], v[100:103], v[212:215], v[76:79]
    ds_read_b64_tr_b16 v[124:125], v21 offset:28672
    ds_read_b64_tr_b16 v[126:127], v21 offset:29184
    s_add_u32 m0, s42, 98304
    s_nop 0
    buffer_load_dwordx4 v13, s[20:23], s43 offen lds
    s_add_u32 s43, s43, 0x2000
    s_waitcnt lgkmcnt(10)
    v_mfma_f32_16x16x32_bf16 v[80:83], v[104:107], v[208:211], v[80:83]
    v_mfma_f32_16x16x32_bf16 v[88:91], v[104:107], v[212:215], v[88:91]
    s_waitcnt lgkmcnt(8)
    v_mfma_f32_16x16x32_bf16 v[84:87], v[108:111], v[208:211], v[84:87]
    s_add_u32 m0, s42, 106496
    s_nop 0
    buffer_load_dwordx4 v13, s[20:23], s43 offen lds
    s_add_u32 s43, s43, 0xe000
    v_mfma_f32_16x16x32_bf16 v[92:95], v[108:111], v[212:215], v[92:95]
    s_waitcnt lgkmcnt(6)
    v_mfma_f32_16x16x32_bf16 v[64:67], v[112:115], v[216:219], v[64:67]
    v_mfma_f32_16x16x32_bf16 v[72:75], v[112:115], v[220:223], v[72:75]
    s_waitcnt vmcnt(14) lgkmcnt(0)
    s_barrier
    v_mfma_f32_16x16x32_bf16 v[68:71], v[116:119], v[216:219], v[68:71]
    ds_read_b64_tr_b16 v[96:97], v22 offset:49152
    ds_read_b64_tr_b16 v[98:99], v22 offset:49664
    s_add_u32 m0, s42, 16384
    s_nop 0
    buffer_load_dwordx4 v13, s[20:23], s43 offen lds
    s_add_u32 s43, s43, 0x2000
    v_mfma_f32_16x16x32_bf16 v[76:79], v[116:119], v[220:223], v[76:79]
    ds_read_b64_tr_b16 v[100:101], v22 offset:57344
    ds_read_b64_tr_b16 v[102:103], v22 offset:57856
    v_mfma_f32_16x16x32_bf16 v[80:83], v[120:123], v[216:219], v[80:83]
    ds_read_b64_tr_b16 v[104:105], v22 offset:53248
    ds_read_b64_tr_b16 v[106:107], v22 offset:53760
    s_add_u32 m0, s42, 24576
    s_nop 0
    buffer_load_dwordx4 v13, s[20:23], s43 offen lds
    s_add_u32 s43, s43, 0xe000
    v_mfma_f32_16x16x32_bf16 v[88:91], v[120:123], v[220:223], v[88:91]
    ds_read_b64_tr_b16 v[108:109], v22 offset:61440
    ds_read_b64_tr_b16 v[110:111], v22 offset:61952
    v_mfma_f32_16x16x32_bf16 v[84:87], v[124:127], v[216:219], v[84:87]
    v_mfma_f32_16x16x32_bf16 v[92:95], v[124:127], v[220:223], v[92:95]
    s_waitcnt vmcnt(4)
    v_cmp_ne_u32 s[58:59], 1, v16
    s_waitcnt lgkmcnt(6)
    v_mfma_f32_16x16x32_bf16 v[64:67], v[96:99], v[224:227], v[64:67]
    ds_read_b64_tr_b16 v[112:113], v24 offset:0
    ds_read_b64_tr_b16 v[114:115], v24 offset:512
    buffer_load_dwordx4 v[176:179], v14, s[28:31], s3 offen offset:0 sc1
    v_mfma_f32_16x16x32_bf16 v[72:75], v[96:99], v[228:231], v[72:75]
    ds_read_b64_tr_b16 v[116:117], v24 offset:8192
    ds_read_b64_tr_b16 v[118:119], v24 offset:8704
    s_waitcnt lgkmcnt(8)
    v_mfma_f32_16x16x32_bf16 v[68:71], v[100:103], v[224:227], v[68:71]
    ds_read_b64_tr_b16 v[120:121], v24 offset:4096
    ds_read_b64_tr_b16 v[122:123], v24 offset:4608
    buffer_load_dwordx4 v[180:183], v14, s[28:31], s3 offen offset:1024 sc1
    v_mfma_f32_16x16x32_bf16 v[76:79], v[100:103], v[228:231], v[76:79]
    ds_read_b64_tr_b16 v[124:125], v24 offset:12288
    ds_read_b64_tr_b16 v[126:127], v24 offset:12800
    s_waitcnt lgkmcnt(10)
    v_mfma_f32_16x16x32_bf16 v[64:67], v[104:107], v[232:235], v[64:67]
    buffer_load_dwordx4 v[184:187], v14, s[28:31], s7 offen offset:0 sc1
    v_mfma_f32_16x16x32_bf16 v[72:75], v[104:107], v[236:239], v[72:75]
    s_waitcnt lgkmcnt(8)
    v_mfma_f32_16x16x32_bf16 v[68:71], v[108:111], v[232:235], v[68:71]
    buffer_load_dwordx4 v[188:191], v14, s[28:31], s7 offen offset:1024 sc1
    v_mfma_f32_16x16x32_bf16 v[76:79], v[108:111], v[236:239], v[76:79]
    s_waitcnt lgkmcnt(6)
    v_mfma_f32_16x16x32_bf16 v[64:67], v[112:115], v[240:243], v[64:67]
    ds_read_b64_tr_b16 v[96:97], v23 offset:49152
    ds_read_b64_tr_b16 v[98:99], v23 offset:49664
    s_waitcnt lgkmcnt(6)
    v_mfma_f32_16x16x32_bf16 v[68:71], v[116:119], v[240:243], v[68:71]
    ds_read_b64_tr_b16 v[100:101], v23 offset:57344
    ds_read_b64_tr_b16 v[102:103], v23 offset:57856
    v_mfma_f32_16x16x32_bf16 v[72:75], v[112:115], v[244:247], v[72:75]
    ds_read_b64_tr_b16 v[104:105], v23 offset:53248
    ds_read_b64_tr_b16 v[106:107], v23 offset:53760
    buffer_load_dwordx4 v[192:195], v14, s[28:31], s48 offen offset:0 sc1
    s_waitcnt lgkmcnt(8)
    v_mfma_f32_16x16x32_bf16 v[64:67], v[120:123], v[248:251], v[64:67]
    ds_read_b64_tr_b16 v[108:109], v23 offset:61440
    ds_read_b64_tr_b16 v[110:111], v23 offset:61952
    s_waitcnt lgkmcnt(8)
    v_mfma_f32_16x16x32_bf16 v[68:71], v[124:127], v[248:251], v[68:71]
    buffer_load_dwordx4 v[196:199], v14, s[28:31], s48 offen offset:1024 sc1
    v_mfma_f32_16x16x32_bf16 v[76:79], v[116:119], v[244:247], v[76:79]
    v_mfma_f32_16x16x32_bf16 v[72:75], v[120:123], v[252:255], v[72:75]
    buffer_load_dwordx4 v[200:203], v14, s[28:31], s99 offen offset:0 sc1
    v_cvt_pk_bf16_f32 v64, v64, v65
    v_pk_max_i16 v64, v64, 0
    v_and_b32 v65, s47, v64
    v_lshlrev_b32 v64, 16, v64
    v_cvt_pk_bf16_f32 v66, v66, v67
    v_mfma_f32_16x16x32_bf16 v[76:79], v[124:127], v[252:255], v[76:79]
    v_pk_max_i16 v66, v66, 0
    v_and_b32 v67, s47, v66
    v_lshlrev_b32 v66, 16, v66
    v_cvt_pk_bf16_f32 v68, 0, v68
    v_cvt_pk_bf16_f32 v69, 0, v69
    s_waitcnt lgkmcnt(6)
    v_mfma_f32_16x16x32_bf16 v[80:83], v[96:99], v[224:227], v[80:83]
    ds_read_b64_tr_b16 v[112:113], v25 offset:0
    ds_read_b64_tr_b16 v[114:115], v25 offset:512
    buffer_load_dwordx4 v[204:207], v14, s[28:31], s99 offen offset:1024 sc1
    v_mul_f32 v64, v64, v68
    v_mul_f32 v65, v65, v69
    v_cvt_pk_bf16_f32 v64, v64, v65
    v_cvt_pk_bf16_f32 v70, 0, v70
    v_cvt_pk_bf16_f32 v71, 0, v71
    s_waitcnt lgkmcnt(6)
    v_mfma_f32_16x16x32_bf16 v[84:87], v[100:103], v[224:227], v[84:87]
    ds_read_b64_tr_b16 v[116:117], v25 offset:8192
    ds_read_b64_tr_b16 v[118:119], v25 offset:8704
    v_mul_f32 v66, v66, v70
    v_mul_f32 v67, v67, v71
    v_cvt_pk_bf16_f32 v65, v66, v67
    v_cvt_pk_bf16_f32 v72, v72, v73
    v_pk_max_i16 v72, v72, 0
    s_waitcnt lgkmcnt(6)
    v_mfma_f32_16x16x32_bf16 v[80:83], v[104:107], v[232:235], v[80:83]
    ds_read_b64_tr_b16 v[120:121], v25 offset:4096
    ds_read_b64_tr_b16 v[122:123], v25 offset:4608
    buffer_load_dwordx4 v[208:211], v14, s[28:31], s100 offen offset:0 sc1
    v_and_b32 v73, s47, v72
    v_lshlrev_b32 v72, 16, v72
    v_cvt_pk_bf16_f32 v74, v74, v75
    v_pk_max_i16 v74, v74, 0
    v_and_b32 v75, s47, v74
    s_waitcnt lgkmcnt(6)
    v_mfma_f32_16x16x32_bf16 v[84:87], v[108:111], v[232:235], v[84:87]
    ds_read_b64_tr_b16 v[124:125], v25 offset:12288
    ds_read_b64_tr_b16 v[126:127], v25 offset:12800
    v_lshlrev_b32 v74, 16, v74
    v_cvt_pk_bf16_f32 v76, 0, v76
    v_cvt_pk_bf16_f32 v77, 0, v77
    v_mul_f32 v72, v72, v76
    v_mul_f32 v73, v73, v77
    v_mfma_f32_16x16x32_bf16 v[88:91], v[96:99], v[228:231], v[88:91]
    buffer_load_dwordx4 v[212:215], v14, s[28:31], s100 offen offset:1024 sc1
    v_cvt_pk_bf16_f32 v66, v72, v73
    v_cvt_pk_bf16_f32 v78, 0, v78
    v_cvt_pk_bf16_f32 v79, 0, v79
    v_mul_f32 v74, v74, v78
    v_mul_f32 v75, v75, v79
    v_mfma_f32_16x16x32_bf16 v[92:95], v[100:103], v[228:231], v[92:95]
    v_cvt_pk_bf16_f32 v67, v74, v75
    v_permlane32_swap_b32 v64, v66
    s_nop 0
    v_permlane32_swap_b32 v65, v67
    buffer_store_dwordx4 v[64:67], v3, s[28:31], s46 offen offset:0 sc1
    s_waitcnt lgkmcnt(6)
    v_mfma_f32_16x16x32_bf16 v[80:83], v[112:115], v[240:243], v[80:83]
    s_waitcnt lgkmcnt(4)
    v_mfma_f32_16x16x32_bf16 v[84:87], v[116:119], v[240:243], v[84:87]
    s_waitcnt lgkmcnt(2)
    v_mfma_f32_16x16x32_bf16 v[80:83], v[120:123], v[248:251], v[80:83]
    s_waitcnt lgkmcnt(0)
    v_mfma_f32_16x16x32_bf16 v[84:87], v[124:127], v[248:251], v[84:87]
    v_mfma_f32_16x16x32_bf16 v[88:91], v[104:107], v[236:239], v[88:91]
    v_mfma_f32_16x16x32_bf16 v[92:95], v[108:111], v[236:239], v[92:95]
    v_mfma_f32_16x16x32_bf16 v[88:91], v[112:115], v[244:247], v[88:91]
    v_mfma_f32_16x16x32_bf16 v[92:95], v[116:119], v[244:247], v[92:95]
    v_mfma_f32_16x16x32_bf16 v[88:91], v[120:123], v[252:255], v[88:91]
    v_mfma_f32_16x16x32_bf16 v[92:95], v[124:127], v[252:255], v[92:95]
    v_cvt_pk_bf16_f32 v80, v80, v81
    v_pk_max_i16 v80, v80, 0
    v_and_b32 v81, s47, v80
    v_lshlrev_b32 v80, 16, v80
    v_cvt_pk_bf16_f32 v82, v82, v83
    v_pk_max_i16 v82, v82, 0
    v_and_b32 v83, s47, v82
    v_lshlrev_b32 v82, 16, v82
    v_cvt_pk_bf16_f32 v84, 0, v84
    v_cvt_pk_bf16_f32 v85, 0, v85
    v_mul_f32 v80, v80, v84
    v_mul_f32 v81, v81, v85
    v_cvt_pk_bf16_f32 v80, v80, v81
    v_cvt_pk_bf16_f32 v86, 0, v86
    v_cvt_pk_bf16_f32 v87, 0, v87
    v_mul_f32 v82, v82, v86
    v_mul_f32 v83, v83, v87
    v_cvt_pk_bf16_f32 v81, v82, v83
    v_cvt_pk_bf16_f32 v88, v88, v89
    v_pk_max_i16 v88, v88, 0
    v_and_b32 v89, s47, v88
    v_lshlrev_b32 v88, 16, v88
    v_cvt_pk_bf16_f32 v90, v90, v91
    v_pk_max_i16 v90, v90, 0
    v_and_b32 v91, s47, v90
    v_lshlrev_b32 v90, 16, v90
    v_cvt_pk_bf16_f32 v92, 0, v92
    v_cvt_pk_bf16_f32 v93, 0, v93
    v_mul_f32 v88, v88, v92
    v_mul_f32 v89, v89, v93
    v_cvt_pk_bf16_f32 v82, v88, v89
    v_cvt_pk_bf16_f32 v94, 0, v94
    v_cvt_pk_bf16_f32 v95, 0, v95
    v_mul_f32 v90, v90, v94
    v_mul_f32 v91, v91, v95
    v_cvt_pk_bf16_f32 v83, v90, v91
    v_permlane32_swap_b32 v80, v82
    s_nop 0
    v_permlane32_swap_b32 v81, v83
    buffer_store_dwordx4 v[80:83], v3, s[28:31], s46 offen offset:2048 sc1
    s_cmp_eq_u64 s[58:59], 0
    s_cbranch_scc0 L_slow
L_join:
    s_mov_b32 s51, 1048576
    s_add_u32 s3, s37, 0x0
    s_add_u32 s7, s37, 0x1000
    s_add_u32 s48, s37, 0x2000
    s_waitcnt vmcnt(12)
    s_barrier
    s_waitcnt vmcnt(11)
    v_mfma_f32_16x16x32_bf16 v[224:227], v[128:131], v[176:179], 0
    ds_read_b64_tr_b16 v[112:113], v4 offset:32768
    buffer_load_dwordx4 v[216:219], v14, s[28:31], s54 offen offset:0 sc1
    s_add_u32 s57, s42, 49152
    v_mfma_f32_16x16x32_bf16 v[228:231], v[132:135], v[176:179], 0
    ds_read_b64_tr_b16 v[114:115], v4 offset:40960
    v_add_u32 v20, s57, v14
    v_mfma_f32_16x16x32_bf16 v[232:235], v[136:139], v[176:179], 0
    ds_read_b64_tr_b16 v[116:117], v5 offset:32768
    v_xor_b32 v21, 0x800, v20
    v_mfma_f32_16x16x32_bf16 v[236:239], v[140:143], v[176:179], 0
    ds_read_b64_tr_b16 v[118:119], v5 offset:40960
    buffer_load_dwordx4 v[220:223], v14, s[28:31], s54 offen offset:1024 sc1
    v_xor_b32 v22, 0x1000, v20
    s_waitcnt vmcnt(12)
    v_mfma_f32_16x16x32_bf16 v[240:243], v[128:131], v[180:183], 0
    ds_read_b64_tr_b16 v[120:121], v6 offset:32768
    v_xor_b32 v23, 0x1800, v20
    v_mfma_f32_16x16x32_bf16 v[244:247], v[132:135], v[180:183], 0
    ds_read_b64_tr_b16 v[122:123], v6 offset:40960
    v_and_b32 v24, 15, v2
    v_mfma_f32_16x16x32_bf16 v[248:251], v[136:139], v[180:183], 0
    ds_read_b64_tr_b16 v[124:125], v7 offset:32768
    buffer_load_dwordx4 v[68:71], v14, s[28:31], s55 offen offset:0 sc1
    v_lshrrev_b32 v3, 4, v2
    v_mfma_f32_16x16x32_bf16 v[252:255], v[140:143], v[180:183], 0
    ds_read_b64_tr_b16 v[126:127], v7 offset:40960
    v_lshlrev_b32 v24, 10, v24
    s_waitcnt vmcnt(12)
    v_mfma_f32_16x16x32_bf16 v[224:227], v[144:147], v[184:187], v[224:227]
    ds_read_b64_tr_b16 v[96:97], v4 offset:49152
    v_lshl_add_u32 v24, v3, 3, v24
    v_mfma_f32_16x16x32_bf16 v[228:231], v[148:151], v[184:187], v[228:231]
    ds_read_b64_tr_b16 v[98:99], v4 offset:57344
    buffer_load_dwordx4 v[72:75], v14, s[28:31], s55 offen offset:1024 sc1
    s_add_u32 s99, s37, 0x3000
    v_mfma_f32_16x16x32_bf16 v[232:235], v[152:155], v[184:187], v[232:235]
    ds_read_b64_tr_b16 v[100:101], v5 offset:49152
    s_add_u32 s100, s37, 0x800
    v_mfma_f32_16x16x32_bf16 v[236:239], v[156:159], v[184:187], v[236:239]
    ds_read_b64_tr_b16 v[102:103], v5 offset:57344
    s_add_u32 s54, s37, 0x1800
    s_waitcnt vmcnt(12)
    v_mfma_f32_16x16x32_bf16 v[240:243], v[144:147], v[188:191], v[240:243]
    ds_read_b64_tr_b16 v[104:105], v6 offset:49152
    s_add_u32 m0, s42, 114688
    s_nop 0
    buffer_load_dwordx4 v13, s[20:23], s43 offen lds
    s_add_u32 s43, s43, 0x2000
    s_add_u32 s55, s37, 0x2800
    v_mfma_f32_16x16x32_bf16 v[244:247], v[148:151], v[188:191], v[244:247]
    ds_read_b64_tr_b16 v[106:107], v6 offset:57344
    s_lshl_b32 s56, s101, 11
    v_mfma_f32_16x16x32_bf16 v[248:251], v[152:155], v[188:191], v[248:251]
    ds_read_b64_tr_b16 v[108:109], v7 offset:49152
    s_sub_u32 s99, s99, s56
    v_mfma_f32_16x16x32_bf16 v[252:255], v[156:159], v[188:191], v[252:255]
    ds_read_b64_tr_b16 v[110:111], v7 offset:57344
    s_add_u32 m0, s42, 122880
    s_nop 0
    buffer_load_dwordx4 v13, s[20:23], s43 offen lds
    s_waitcnt vmcnt(13)
    v_mfma_f32_16x16x32_bf16 v[224:227], v[32:35], v[192:195], v[224:227]
    ds_read_b64_tr_b16 v[80:81], v30 offset:16384
    v_mfma_f32_16x16x32_bf16 v[228:231], v[36:39], v[192:195], v[228:231]
    ds_read_b64_tr_b16 v[82:83], v30 offset:24576
    v_mfma_f32_16x16x32_bf16 v[232:235], v[40:43], v[192:195], v[232:235]
    ds_read_b64_tr_b16 v[84:85], v31 offset:16384
    buffer_load_dwordx4 v[128:131], v14, s[28:31], s3 offen offset:0 sc1
    v_mfma_f32_16x16x32_bf16 v[236:239], v[44:47], v[192:195], v[236:239]
    ds_read_b64_tr_b16 v[86:87], v31 offset:24576
    s_waitcnt vmcnt(13)
    v_mfma_f32_16x16x32_bf16 v[240:243], v[32:35], v[196:199], v[240:243]
    ds_read_b64_tr_b16 v[88:89], v8 offset:16384
    v_mfma_f32_16x16x32_bf16 v[244:247], v[36:39], v[196:199], v[244:247]
    ds_read_b64_tr_b16 v[90:91], v8 offset:24576
    buffer_load_dwordx4 v[132:135], v14, s[28:31], s3 offen offset:1024 sc1
    v_mfma_f32_16x16x32_bf16 v[248:251], v[40:43], v[196:199], v[248:251]
    ds_read_b64_tr_b16 v[92:93], v9 offset:16384
    v_mfma_f32_16x16x32_bf16 v[252:255], v[44:47], v[196:199], v[252:255]
    ds_read_b64_tr_b16 v[94:95], v9 offset:24576
    s_waitcnt vmcnt(13)
    v_mfma_f32_16x16x32_bf16 v[224:227], v[48:51], v[200:203], v[224:227]
    ds_read_b64_tr_b16 v[32:33], v26 offset:0
    buffer_load_dwordx4 v[136:139], v14, s[28:31], s7 offen offset:0 sc1
    v_mfma_f32_16x16x32_bf16 v[228:231], v[52:55], v[200:203], v[228:231]
    ds_read_b64_tr_b16 v[34:35], v26 offset:8192
    v_mfma_f32_16x16x32_bf16 v[232:235], v[56:59], v[200:203], v[232:235]
    ds_read_b64_tr_b16 v[36:37], v27 offset:0
    v_mfma_f32_16x16x32_bf16 v[236:239], v[60:63], v[200:203], v[236:239]
    ds_read_b64_tr_b16 v[38:39], v27 offset:8192
    buffer_load_dwordx4 v[140:143], v14, s[28:31], s7 offen offset:1024 sc1
    s_waitcnt vmcnt(14)
    v_mfma_f32_16x16x32_bf16 v[240:243], v[48:51], v[204:207], v[240:243]
    ds_read_b64_tr_b16 v[40:41], v28 offset:0
    v_mfma_f32_16x16x32_bf16 v[244:247], v[52:55], v[204:207], v[244:247]
    ds_read_b64_tr_b16 v[42:43], v28 offset:8192
    v_mfma_f32_16x16x32_bf16 v[248:251], v[56:59], v[204:207], v[248:251]
    ds_read_b64_tr_b16 v[44:45], v29 offset:0
    buffer_load_dwordx4 v[144:147], v14, s[28:31], s48 offen offset:0 sc1
    v_mfma_f32_16x16x32_bf16 v[252:255], v[60:63], v[204:207], v[252:255]
    ds_read_b64_tr_b16 v[46:47], v29 offset:8192
    s_waitcnt vmcnt(14)
    v_mfma_f32_16x16x32_bf16 v[224:227], v[160:163], v[208:211], v[224:227]
    ds_read_b64_tr_b16 v[48:49], v26 offset:16384
    v_mfma_f32_16x16x32_bf16 v[228:231], v[164:167], v[208:211], v[228:231]
    ds_read_b64_tr_b16 v[50:51], v26 offset:24576
    buffer_load_dwordx4 v[148:151], v14, s[28:31], s48 offen offset:1024 sc1
    v_mfma_f32_16x16x32_bf16 v[232:235], v[168:171], v[208:211], v[232:235]
    ds_read_b64_tr_b16 v[52:53], v27 offset:16384
    v_mfma_f32_16x16x32_bf16 v[236:239], v[172:175], v[208:211], v[236:239]
    ds_read_b64_tr_b16 v[54:55], v27 offset:24576
    s_waitcnt vmcnt(14)
    v_mfma_f32_16x16x32_bf16 v[240:243], v[160:163], v[212:215], v[240:243]
    ds_read_b64_tr_b16 v[56:57], v28 offset:16384
    v_mfma_f32_16x16x32_bf16 v[244:247], v[164:167], v[212:215], v[244:247]
    ds_read_b64_tr_b16 v[58:59], v28 offset:24576
    v_mfma_f32_16x16x32_bf16 v[248:251], v[168:171], v[212:215], v[248:251]
    ds_read_b64_tr_b16 v[60:61], v29 offset:16384
    v_mfma_f32_16x16x32_bf16 v[252:255], v[172:175], v[212:215], v[252:255]
    ds_read_b64_tr_b16 v[62:63], v29 offset:24576
    s_waitcnt vmcnt(11) lgkmcnt(15)
    v_mfma_f32_16x16x32_bf16 v[224:227], v[112:115], v[216:219], v[224:227]
    ds_read_b64_tr_b16 v[160:161], v4 offset:0
    v_mfma_f32_16x16x32_bf16 v[228:231], v[116:119], v[216:219], v[228:231]
    ds_read_b64_tr_b16 v[162:163], v4 offset:8192
    v_mfma_f32_16x16x32_bf16 v[232:235], v[120:123], v[216:219], v[232:235]
    ds_read_b64_tr_b16 v[164:165], v5 offset:0
    v_mfma_f32_16x16x32_bf16 v[236:239], v[124:127], v[216:219], v[236:239]
    ds_read_b64_tr_b16 v[166:167], v5 offset:8192
    s_waitcnt vmcnt(10)
    v_mfma_f32_16x16x32_bf16 v[240:243], v[112:115], v[220:223], v[240:243]
    ds_read_b64_tr_b16 v[168:169], v6 offset:0
    v_mfma_f32_16x16x32_bf16 v[244:247], v[116:119], v[220:223], v[244:247]
    ds_read_b64_tr_b16 v[170:171], v6 offset:8192
    v_mfma_f32_16x16x32_bf16 v[248:251], v[120:123], v[220:223], v[248:251]
    ds_read_b64_tr_b16 v[172:173], v7 offset:0
    v_mfma_f32_16x16x32_bf16 v[252:255], v[124:127], v[220:223], v[252:255]
    ds_read_b64_tr_b16 v[174:175], v7 offset:8192
    buffer_load_dwordx4 v[152:155], v14, s[28:31], s99 offen offset:0 sc1
    s_waitcnt vmcnt(10)
    v_mfma_f32_16x16x32_bf16 v[224:227], v[96:99], v[68:71], v[224:227]
    ds_read_b64_tr_b16 v[200:201], v26 offset:32768
    v_mfma_f32_16x16x32_bf16 v[228:231], v[100:103], v[68:71], v[228:231]
    ds_read_b64_tr_b16 v[202:203], v26 offset:40960
    v_mfma_f32_16x16x32_bf16 v[232:235], v[104:107], v[68:71], v[232:235]
    ds_read_b64_tr_b16 v[204:205], v27 offset:32768
    buffer_load_dwordx4 v[176:179], v14, s[28:31], s100 offen offset:0 sc1
    v_mfma_f32_16x16x32_bf16 v[236:239], v[108:111], v[68:71], v[236:239]
    s_waitcnt vmcnt(7)
    v_max_u32 v25, v129, v130
    ds_read_b64_tr_b16 v[206:207], v27 offset:40960
    v_mfma_f32_16x16x32_bf16 v[240:243], v[96:99], v[72:75], v[240:243]
    s_waitcnt vmcnt(6)
    v_max3_u32 v25, v25, v133, v134
    ds_read_b64_tr_b16 v[208:209], v28 offset:32768
    v_mfma_f32_16x16x32_bf16 v[244:247], v[100:103], v[72:75], v[244:247]
    v_cmp_eq_u32 vcc, -1, v25
    ds_read_b64_tr_b16 v[210:211], v28 offset:40960
    buffer_load_dwordx4 v[184:187], v14, s[28:31], s54 offen offset:0 sc1
    v_mfma_f32_16x16x32_bf16 v[248:251], v[104:107], v[72:75], v[248:251]
    s_cbranch_vccnz L_rt7
L_bk7:
    ds_read_b64_tr_b16 v[212:213], v29 offset:32768
    v_mfma_f32_16x16x32_bf16 v[252:255], v[108:111], v[72:75], v[252:255]
    ds_read_b64_tr_b16 v[214:215], v29 offset:40960
    v_mfma_f32_16x16x32_bf16 v[224:227], v[80:83], v[128:131], v[224:227]
    ds_read_b64_tr_b16 v[112:113], v4 offset:16384
    buffer_load_dwordx4 v[192:195], v14, s[28:31], s55 offen offset:0 sc1
    v_mfma_f32_16x16x32_bf16 v[228:231], v[84:87], v[128:131], v[228:231]
    ds_read_b64_tr_b16 v[114:115], v4 offset:24576
    v_mfma_f32_16x16x32_bf16 v[232:235], v[88:91], v[128:131], v[232:235]
    ds_read_b64_tr_b16 v[116:117], v5 offset:16384
    v_mfma_f32_16x16x32_bf16 v[236:239], v[92:95], v[128:131], v[236:239]
    s_waitcnt vmcnt(7)
    v_max_u32 v25, v137, v138
    ds_read_b64_tr_b16 v[118:119], v5 offset:24576
    buffer_load_dwordx4 v[156:159], v14, s[28:31], s99 offen offset:1024 sc1
    v_mfma_f32_16x16x32_bf16 v[240:243], v[80:83], v[132:135], v[240:243]
    s_waitcnt vmcnt(7)
    v_max3_u32 v25, v25, v141, v142
    ds_read_b64_tr_b16 v[120:121], v6 offset:16384
    v_mfma_f32_16x16x32_bf16 v[244:247], v[84:87], v[132:135], v[244:247]
    v_cmp_eq_u32 vcc, -1, v25
    ds_read_b64_tr_b16 v[122:123], v6 offset:24576
    v_mfma_f32_16x16x32_bf16 v[248:251], v[88:91], v[132:135], v[248:251]
    s_cbranch_vccnz L_rt8
L_bk8:
    ds_read_b64_tr_b16 v[124:125], v7 offset:16384
    buffer_load_dwordx4 v[180:183], v14, s[28:31], s100 offen offset:1024 sc1
    v_mfma_f32_16x16x32_bf16 v[252:255], v[92:95], v[132:135], v[252:255]
    ds_read_b64_tr_b16 v[126:127], v7 offset:24576
    s_waitcnt lgkmcnt(15)
    s_barrier
    v_mfma_f32_16x16x32_bf16 v[224:227], v[32:35], v[136:139], v[224:227]
    ds_read_b64_tr_b16 v[96:97], v26 offset:49152
    ds_read_b64_tr_b16 v[98:99], v26 offset:57344
    v_mfma_f32_16x16x32_bf16 v[228:231], v[36:39], v[136:139], v[228:231]
    ds_read_b64_tr_b16 v[100:101], v27 offset:49152
    ds_read_b64_tr_b16 v[102:103], v27 offset:57344
    buffer_load_dwordx4 v[188:191], v14, s[28:31], s54 offen offset:1024 sc1
    v_mfma_f32_16x16x32_bf16 v[232:235], v[40:43], v[136:139], v[232:235]
    ds_read_b64_tr_b16 v[104:105], v28 offset:49152
    ds_read_b64_tr_b16 v[106:107], v28 offset:57344
    v_mfma_f32_16x16x32_bf16 v[236:239], v[44:47], v[136:139], v[236:239]
    s_waitcnt vmcnt(8)
    v_max_u32 v25, v145, v146
    ds_read_b64_tr_b16 v[108:109], v29 offset:49152
    ds_read_b64_tr_b16 v[110:111], v29 offset:57344
    v_mfma_f32_16x16x32_bf16 v[240:243], v[32:35], v[140:143], v[240:243]
    s_waitcnt vmcnt(7)
    v_max3_u32 v25, v25, v149, v150
    buffer_load_dwordx4 v[196:199], v14, s[28:31], s55 offen offset:1024 sc1
    v_mfma_f32_16x16x32_bf16 v[244:247], v[36:39], v[140:143], v[244:247]
    v_cmp_eq_u32 vcc, -1, v25
    v_mfma_f32_16x16x32_bf16 v[248:251], v[40:43], v[140:143], v[248:251]
    s_cbranch_vccnz L_rt9
L_bk9:
    v_mfma_f32_16x16x32_bf16 v[252:255], v[44:47], v[140:143], v[252:255]
    v_mfma_f32_16x16x32_bf16 v[224:227], v[48:51], v[144:147], v[224:227]
    v_mfma_f32_16x16x32_bf16 v[228:231], v[52:55], v[144:147], v[228:231]
    v_mfma_f32_16x16x32_bf16 v[232:235], v[56:59], v[144:147], v[232:235]
    v_mfma_f32_16x16x32_bf16 v[236:239], v[60:63], v[144:147], v[236:239]
    s_waitcnt vmcnt(7)
    v_max_u32 v25, v153, v154
    v_mfma_f32_16x16x32_bf16 v[240:243], v[48:51], v[148:151], v[240:243]
    s_waitcnt vmcnt(6)
    v_max3_u32 v25, v25, v177, v178
    v_mfma_f32_16x16x32_bf16 v[244:247], v[52:55], v[148:151], v[244:247]
    v_cmp_eq_u32 vcc, -1, v25
    v_mfma_f32_16x16x32_bf16 v[248:251], v[56:59], v[148:151], v[248:251]
    s_cbranch_vccnz L_rt10
L_bk10:
    v_mfma_f32_16x16x32_bf16 v[252:255], v[60:63], v[148:151], v[252:255]
    v_mfma_f32_16x16x32_bf16 v[224:227], v[160:163], v[152:155], v[224:227]
    v_mfma_f32_16x16x32_bf16 v[228:231], v[164:167], v[152:155], v[228:231]
    v_mfma_f32_16x16x32_bf16 v[232:235], v[168:171], v[152:155], v[232:235]
    v_mfma_f32_16x16x32_bf16 v[236:239], v[172:175], v[152:155], v[236:239]
    s_waitcnt vmcnt(5)
    v_max_u32 v25, v185, v186
    s_waitcnt lgkmcnt(15)
    v_mfma_f32_16x16x32_bf16 v[224:227], v[200:203], v[176:179], v[224:227]
    s_waitcnt vmcnt(4)
    v_max3_u32 v25, v25, v193, v194
    v_mfma_f32_16x16x32_bf16 v[228:231], v[204:207], v[176:179], v[228:231]
    v_cmp_eq_u32 vcc, -1, v25
    v_mfma_f32_16x16x32_bf16 v[232:235], v[208:211], v[176:179], v[232:235]
    s_cbranch_vccnz L_rt11
L_bk11:
    v_mfma_f32_16x16x32_bf16 v[236:239], v[212:215], v[176:179], v[236:239]
    s_waitcnt lgkmcnt(14)
    v_mfma_f32_16x16x32_bf16 v[224:227], v[112:115], v[184:187], v[224:227]
    s_waitcnt lgkmcnt(12)
    v_mfma_f32_16x16x32_bf16 v[228:231], v[116:119], v[184:187], v[228:231]
    s_waitcnt lgkmcnt(10)
    v_mfma_f32_16x16x32_bf16 v[232:235], v[120:123], v[184:187], v[232:235]
    s_waitcnt lgkmcnt(8)
    v_mfma_f32_16x16x32_bf16 v[236:239], v[124:127], v[184:187], v[236:239]
    s_waitcnt vmcnt(3)
    v_max_u32 v25, v157, v158
    s_waitcnt lgkmcnt(4)
    v_mfma_f32_16x16x32_bf16 v[228:231], v[100:103], v[192:195], v[228:231]
    s_waitcnt vmcnt(2)
    v_max3_u32 v25, v25, v181, v182
    s_waitcnt lgkmcnt(2)
    v_mfma_f32_16x16x32_bf16 v[232:235], v[104:107], v[192:195], v[232:235]
    v_cmp_eq_u32 vcc, -1, v25
    s_waitcnt lgkmcnt(0)
    v_mfma_f32_16x16x32_bf16 v[236:239], v[108:111], v[192:195], v[236:239]
    s_cbranch_vccnz L_rt12
L_bk12:
    v_mfma_f32_16x16x32_bf16 v[224:227], v[96:99], v[192:195], v[224:227]
    v_mfma_f32_16x16x32_bf16 v[240:243], v[160:163], v[156:159], v[240:243]
    ds_write_b128 v20, v[228:231] offset:0
    v_mfma_f32_16x16x32_bf16 v[244:247], v[164:167], v[156:159], v[244:247]
    ds_write_b128 v20, v[232:235] offset:8192
    v_mfma_f32_16x16x32_bf16 v[248:251], v[168:171], v[156:159], v[248:251]
    v_mfma_f32_16x16x32_bf16 v[252:255], v[172:175], v[156:159], v[252:255]
    s_waitcnt vmcnt(1)
    v_max_u32 v25, v189, v190
    ds_write_b128 v20, v[236:239] offset:16384
    v_mfma_f32_16x16x32_bf16 v[240:243], v[200:203], v[180:183], v[240:243]
    s_waitcnt vmcnt(0)
    v_max3_u32 v25, v25, v197, v198
    v_mfma_f32_16x16x32_bf16 v[244:247], v[204:207], v[180:183], v[244:247]
    v_cmp_eq_u32 vcc, -1, v25
    v_mfma_f32_16x16x32_bf16 v[248:251], v[208:211], v[180:183], v[248:251]
    s_cbranch_vccnz L_rt13
L_bk13:
    s_waitcnt lgkmcnt(0)
    s_barrier
    v_mfma_f32_16x16x32_bf16 v[252:255], v[212:215], v[180:183], v[252:255]
    ds_read_b128 v[64:67], v21 offset:0
    ds_read_b128 v[68:71], v22 offset:8192
    ds_read_b128 v[72:75], v23 offset:16384
    v_mfma_f32_16x16x32_bf16 v[240:243], v[112:115], v[188:191], v[240:243]
    v_mfma_f32_16x16x32_bf16 v[244:247], v[116:119], v[188:191], v[244:247]
    s_waitcnt lgkmcnt(2)
    v_add_f32 v224, v224, v64
    v_add_f32 v225, v225, v65
    v_mfma_f32_16x16x32_bf16 v[248:251], v[120:123], v[188:191], v[248:251]
    v_add_f32 v226, v226, v66
    v_add_f32 v227, v227, v67
    s_waitcnt lgkmcnt(0)
    v_mfma_f32_16x16x32_bf16 v[252:255], v[124:127], v[188:191], v[252:255]
    v_add_f32 v68, v68, v72
    v_add_f32 v69, v69, v73
    v_add_f32 v70, v70, v74
    v_mfma_f32_16x16x32_bf16 v[244:247], v[100:103], v[196:199], v[244:247]
    v_add_f32 v71, v71, v75
    v_add_f32 v224, v224, v68
    v_add_f32 v225, v225, v69
    v_mfma_f32_16x16x32_bf16 v[248:251], v[104:107], v[196:199], v[248:251]
    v_add_f32 v226, v226, v70
    v_add_f32 v227, v227, v71
    v_cvt_pk_bf16_f32 v224, v224, v225
    v_mfma_f32_16x16x32_bf16 v[252:255], v[108:111], v[196:199], v[252:255]
    v_cvt_pk_bf16_f32 v225, v226, v227
    buffer_store_dwordx2 v[224:225], v24, s[24:27], s52 offen
    v_mfma_f32_16x16x32_bf16 v[240:243], v[96:99], v[196:199], v[240:243]
    ds_write_b128 v20, v[244:247] offset:24576
    ds_write_b128 v20, v[248:251] offset:32768
    s_nop 2
    ds_write_b128 v20, v[252:255] offset:40960
    s_waitcnt lgkmcnt(0)
    s_barrier
    ds_read_b128 v[228:231], v21 offset:24576
    ds_read_b128 v[232:235], v22 offset:32768
    ds_read_b128 v[236:239], v23 offset:40960
    s_waitcnt lgkmcnt(2)
    v_add_f32 v240, v240, v228
    v_add_f32 v241, v241, v229
    v_add_f32 v242, v242, v230
    v_add_f32 v243, v243, v231
    s_waitcnt lgkmcnt(0)
    v_add_f32 v232, v232, v236
    v_add_f32 v233, v233, v237
    v_add_f32 v234, v234, v238
    v_add_f32 v235, v235, v239
    v_add_f32 v240, v240, v232
    v_add_f32 v241, v241, v233
    v_add_f32 v242, v242, v234
    v_add_f32 v243, v243, v235
    v_cvt_pk_bf16_f32 v240, v240, v241
    v_cvt_pk_bf16_f32 v241, v242, v243
    buffer_store_dwordx2 v[240:241], v24, s[24:27], s53 offen
L_end:
    s_endpgm
L_slow:
    buffer_load_dword v16, v15, s[28:31], s50 offen offset:0 sc1
    s_mov_b32 s51, 1048576
L_poll_a:
    s_waitcnt vmcnt(0)
    v_cmp_ne_u32 vcc, 1, v16
    s_cbranch_vccz L_ready_a
    buffer_load_dword v16, v15, s[28:31], s50 offen offset:0 sc1
    s_sub_u32 s51, s51, 1
    s_cmp_lg_u32 s51, 0
    s_cbranch_scc1 L_poll_a
L_ready_a:
    buffer_load_dwordx4 v[176:179], v14, s[28:31], s3 offen offset:0 sc1
    buffer_load_dwordx4 v[180:183], v14, s[28:31], s3 offen offset:1024 sc1
    buffer_load_dwordx4 v[184:187], v14, s[28:31], s7 offen offset:0 sc1
    buffer_load_dwordx4 v[188:191], v14, s[28:31], s7 offen offset:1024 sc1
    buffer_load_dwordx4 v[192:195], v14, s[28:31], s48 offen offset:0 sc1
    buffer_load_dwordx4 v[196:199], v14, s[28:31], s48 offen offset:1024 sc1
    buffer_load_dwordx4 v[200:203], v14, s[28:31], s99 offen offset:0 sc1
    buffer_load_dwordx4 v[204:207], v14, s[28:31], s99 offen offset:1024 sc1
    buffer_load_dwordx4 v[208:211], v14, s[28:31], s100 offen offset:0 sc1
    buffer_load_dwordx4 v[212:215], v14, s[28:31], s100 offen offset:1024 sc1
    s_waitcnt vmcnt(0)
    s_branch L_join
L_rt7:
    s_cmp_eq_u32 s51, 0
    s_cbranch_scc1 L_bk7
    s_sub_u32 s51, s51, 1
    buffer_load_dwordx4 v[128:131], v14, s[28:31], s3 offen offset:0 sc1
    buffer_load_dwordx4 v[132:135], v14, s[28:31], s3 offen offset:1024 sc1
    s_waitcnt vmcnt(0)
    v_max_u32 v25, v129, v130
    v_max3_u32 v25, v25, v133, v134
    v_cmp_eq_u32 vcc, -1, v25
    s_cbranch_vccnz L_rt7
    s_branch L_bk7
L_rt8:
    s_cmp_eq_u32 s51, 0
    s_cbranch_scc1 L_bk8
    s_sub_u32 s51, s51, 1
    buffer_load_dwordx4 v[136:139], v14, s[28:31], s7 offen offset:0 sc1
    buffer_load_dwordx4 v[140:143], v14, s[28:31], s7 offen offset:1024 sc1
    s_waitcnt vmcnt(0)
    v_max_u32 v25, v137, v138
    v_max3_u32 v25, v25, v141, v142
    v_cmp_eq_u32 vcc, -1, v25
    s_cbranch_vccnz L_rt8
    s_branch L_bk8
L_rt9:
    s_cmp_eq_u32 s51, 0
    s_cbranch_scc1 L_bk9
    s_sub_u32 s51, s51, 1
    buffer_load_dwordx4 v[144:147], v14, s[28:31], s48 offen offset:0 sc1
    buffer_load_dwordx4 v[148:151], v14, s[28:31], s48 offen offset:1024 sc1
    s_waitcnt vmcnt(0)
    v_max_u32 v25, v145, v146
    v_max3_u32 v25, v25, v149, v150
    v_cmp_eq_u32 vcc, -1, v25
    s_cbranch_vccnz L_rt9
    s_branch L_bk9
L_rt10:
    s_cmp_eq_u32 s51, 0
    s_cbranch_scc1 L_bk10
    s_sub_u32 s51, s51, 1
    buffer_load_dwordx4 v[152:155], v14, s[28:31], s99 offen offset:0 sc1
    buffer_load_dwordx4 v[176:179], v14, s[28:31], s100 offen offset:0 sc1
    s_waitcnt vmcnt(0)
    v_max_u32 v25, v153, v154
    v_max3_u32 v25, v25, v177, v178
    v_cmp_eq_u32 vcc, -1, v25
    s_cbranch_vccnz L_rt10
    s_branch L_bk10
L_rt11:
    s_cmp_eq_u32 s51, 0
    s_cbranch_scc1 L_bk11
    s_sub_u32 s51, s51, 1
    buffer_load_dwordx4 v[184:187], v14, s[28:31], s54 offen offset:0 sc1
    buffer_load_dwordx4 v[192:195], v14, s[28:31], s55 offen offset:0 sc1
    s_waitcnt vmcnt(0)
    v_max_u32 v25, v185, v186
    v_max3_u32 v25, v25, v193, v194
    v_cmp_eq_u32 vcc, -1, v25
    s_cbranch_vccnz L_rt11
    s_branch L_bk11
L_rt12:
    s_cmp_eq_u32 s51, 0
    s_cbranch_scc1 L_bk12
    s_sub_u32 s51, s51, 1
    buffer_load_dwordx4 v[156:159], v14, s[28:31], s99 offen offset:1024 sc1
    buffer_load_dwordx4 v[180:183], v14, s[28:31], s100 offen offset:1024 sc1
    s_waitcnt vmcnt(0)
    v_max_u32 v25, v157, v158
    v_max3_u32 v25, v25, v181, v182
    v_cmp_eq_u32 vcc, -1, v25
    s_cbranch_vccnz L_rt12
    s_branch L_bk12
L_rt13:
    s_cmp_eq_u32 s51, 0
    s_cbranch_scc1 L_bk13
    s_sub_u32 s51, s51, 1
    buffer_load_dwordx4 v[188:191], v14, s[28:31], s54 offen offset:1024 sc1
    buffer_load_dwordx4 v[196:199], v14, s[28:31], s55 offen offset:1024 sc1
    s_waitcnt vmcnt(0)
    v_max_u32 v25, v189, v190
    v_max3_u32 v25, v25, v197, v198
    v_cmp_eq_u32 vcc, -1, v25
    s_cbranch_vccnz L_rt13
    s_branch L_bk13
L_p2only:
    s_lshr_b32 s52, s35, 3
    s_lshl_b32 s56, s34, 2
    s_add_u32 s52, s52, s56
    s_and_b32 s53, s35, 7
    s_and_b32 s54, s36, 1
    s_lshr_b32 s55, s36, 1
    s_lshr_b32 s56, s35, 3
    s_lshl_b32 s56, s56, 1
    s_add_u32 s56, s56, s53
    s_sub_u32 s57, s56, 7
    s_cmp_ge_u32 s56, 7
    s_cselect_b32 s56, s57, s56
    s_sub_u32 s6, 7, s56
    s_mul_i32 s57, s55, 7
    s_add_u32 s57, s57, s56
    s_lshl_b32 s43, s57, 15
    s_lshl_b32 s56, s54, 14
    s_lshl_b32 s38, s53, 7
    s_add_u32 s38, s38, s56
    s_add_u32 s43, s43, s38
    s_and_b32 s101, s55, 1
    s_mul_i32 s58, s55, 7
    s_add_u32 s37, s58, s101
    s_add_u32 s37, s37, 28
    s_lshl_b32 s56, s37, 15
    s_add_u32 s38, s38, s56
    s_mul_i32 s101, s101, 7
    s_lshl_b32 s56, s52, 1
    s_add_u32 s56, s56, s54
    s_mul_i32 s3, s56, 56
    s_add_u32 s37, s37, s3
    s_lshl_b32 s37, s37, 11
    s_add_u32 s3, s3, s57
    s_lshl_b32 s3, s3, 11
    s_lshr_b32 s58, s58, 1
    s_lshl_b32 s50, s56, 4
    s_add_u32 s50, s50, s58
    s_lshl_b32 s50, s50, 3
    s_add_u32 s50, s50, 7340032
    s_lshl_b32 s52, s56, 15
    s_lshl_b32 s53, s53, 7
    s_add_u32 s52, s52, s53
    s_lshl_b32 s53, s55, 5
    s_add_u32 s52, s52, s53
    s_add_u32 s53, s52, 0x4000
    s_movk_i32 s57, 0x800
    s_cmp_eq_u32 s6, 1
    s_cselect_b32 s56, 0xffffd000, s57
    s_add_u32 s7, s3, s56
    s_cmp_eq_u32 s6, 2
    s_cselect_b32 s56, 0xffffd000, s57
    s_add_u32 s48, s7, s56
    s_cmp_eq_u32 s6, 3
    s_cselect_b32 s56, 0xffffd000, s57
    s_add_u32 s99, s48, s56
    s_cmp_eq_u32 s6, 4
    s_cselect_b32 s56, 0xffffd000, s57
    s_add_u32 s100, s99, s56
    s_cmp_eq_u32 s6, 5
    s_cselect_b32 s56, 0xffffd000, s57
    s_add_u32 s54, s100, s56
    s_cmp_eq_u32 s6, 6
    s_cselect_b32 s56, 0xffffd000, s57
    s_add_u32 s55, s54, s56
    v_lshrrev_b32 v3, 3, v2
    v_bfe_u32 v4, v2, 1, 2
    v_lshrrev_b32 v5, 4, v2
    v_xor_b32 v4, v4, v5
    v_lshlrev_b32 v4, 5, v4
    v_and_b32 v5, 1, v2
    v_lshl_add_u32 v4, v5, 4, v4
    v_lshl_add_u32 v13, v3, 10, v4
    v_lshlrev_b32 v14, 4, v2
    v_lshrrev_b32 v3, 2, v2
    v_lshlrev_b32 v3, 7, v3
    v_and_b32 v4, 3, v2
    v_lshl_add_u32 v3, v4, 3, v3
    v_lshrrev_b32 v8, 1, v1
    v_lshl_add_u32 v3, v8, 11, v3
    v_bfe_u32 v9, v2, 3, 2
    v_xor_b32 v9, v9, v8
    v_xor_b32 v8, 0, v9
    v_lshl_add_u32 v4, v8, 5, v3
    v_xor_b32 v8, 1, v9
    v_lshl_add_u32 v5, v8, 5, v3
    v_xor_b32 v8, 2, v9
    v_lshl_add_u32 v6, v8, 5, v3
    v_xor_b32 v8, 3, v9
    v_lshl_add_u32 v7, v8, 5, v3
    v_min_u32 v15, 7, v2
    v_lshlrev_b32 v15, 2, v15
    v_mov_b32 v18, 1
    v_mov_b32 v19, 0
    v_add_u32 v26, 0x10000, v4
    v_add_u32 v27, 0x10000, v5
    v_add_u32 v28, 0x10000, v6
    v_add_u32 v29, 0x10000, v7
    v_add_u32 v30, 0x20000, v4
    v_add_u32 v31, 0x20000, v5
    v_add_u32 v8, 0x20000, v6
    v_add_u32 v9, 0x20000, v7
    s_waitcnt lgkmcnt(0)
    s_cmp_lg_u32 s2, 255
    s_cbranch_scc1 L_noinit
    v_mov_b32 v48, 0
    v_mov_b32 v49, 0
    v_mov_b32 v50, 0
    v_mov_b32 v51, 0
    s_lshl_b32 s56, s36, 11
    s_add_u32 s56, s56, 7340032
    buffer_store_dwordx4 v[48:51], v14, s[28:31], s56 offen sc1
    buffer_store_dwordx4 v[48:51], v14, s[28:31], s56 offen offset:1024 sc1
L_noinit:
    v_lshrrev_b32 v100, 3, v2
    v_and_b32 v101, 7, v2
    s_and_b32 s56, s34, 3
    s_mul_i32 s56, s56, 7
    v_add_u32 v102, s56, v101
    v_and_b32 v103, -2, v102
    v_add_u32 v103, v103, v100
    v_and_b32 v103, 7, v103
    s_lshr_b32 s56, s34, 2
    s_lshl_b32 s56, s56, 2
    s_add_u32 s56, s56, s35
    s_sub_u32 s56, s56, 28
    s_lshl_b32 s56, s56, 3
    s_add_u32 s56, s56, s36
    v_lshl_add_u32 v103, v103, 6, s56
    v_mul_lo_u32 v103, v103, s39
    v_lshrrev_b32 v106, 1, v102
    v_lshl_add_u32 v103, v106, 7, v103
    v_and_b32 v106, 1, v102
    v_cmp_eq_u32 s[58:59], 1, v106
    s_mov_b32 s56, 0x7f7f7f7f
    s_mov_b32 s57, 0x7f7f7f7f
    s_and_b64 exec, s[56:57], s[58:59]
    buffer_load_dword v107, v103, s[12:15], 0 offen offset:1792 sc1
    buffer_load_dword v108, v103, s[16:19], 0 offen offset:1792 sc1
    s_mov_b64 exec, -1
    s_cmp_lg_u32 s2, 255
    s_cbranch_scc1 L_noinit2
    s_waitcnt vmcnt(2)
    s_barrier
    s_cmp_lg_u32 s36, 0
    s_cbranch_scc1 L_noinit2
    s_mov_b64 exec, 1
    global_store_dword v19, v18, s[32:33] sc1
    s_mov_b64 exec, -1
L_noinit2:
    s_waitcnt vmcnt(0)
    v_lshlrev_b32 v100, 7, v0
    s_sub_u32 s56, s2, 224
    s_mul_i32 s56, s56, 57344
    s_cmp_eq_u32 s36, 7
    s_cbranch_scc1 L_t1
    buffer_load_dword v101, v100, s[20:23], s56 offen sc1
L_t1:
    v_lshrrev_b32 v102, 2, v0
    v_and_b32 v103, 3, v0
    v_lshlrev_b32 v102, 10, v102
    v_lshl_add_u32 v102, v103, 7, v102
    s_waitcnt vmcnt(0)
    s_add_u32 m0, s42, 32768
    s_nop 0
    buffer_load_dwordx4 v13, s[20:23], s43 offen lds
    s_add_u32 s43, s43, 0x2000
    s_add_u32 m0, s42, 40960
    s_nop 0
    buffer_load_dwordx4 v13, s[20:23], s43 offen lds
    s_add_u32 s43, s43, 0x6000
    s_sub_u32 s6, s6, 1
    s_cmp_eq_u32 s6, 0
    s_cselect_b32 s56, 229376, 0
    s_cselect_b32 s6, 7, s6
    s_sub_u32 s43, s43, s56
    s_add_u32 m0, s42, 49152
    s_nop 0
    buffer_load_dwordx4 v13, s[20:23], s43 offen lds
    s_add_u32 s43, s43, 0x2000
    s_add_u32 m0, s42, 57344
    s_nop 0
    buffer_load_dwordx4 v13, s[20:23], s43 offen lds
    s_add_u32 s43, s43, 0x6000
    s_sub_u32 s6, s6, 1
    s_cmp_eq_u32 s6, 0
    s_cselect_b32 s56, 229376, 0
    s_cselect_b32 s6, 7, s6
    s_sub_u32 s43, s43, s56
    s_add_u32 m0, s42, 65536
    s_nop 0
    buffer_load_dwordx4 v13, s[20:23], s43 offen lds
    s_add_u32 s43, s43, 0x2000
    s_add_u32 m0, s42, 73728
    s_nop 0
    buffer_load_dwordx4 v13, s[20:23], s43 offen lds
    s_add_u32 s43, s43, 0x6000
    s_sub_u32 s6, s6, 1
    s_cmp_eq_u32 s6, 0
    s_cselect_b32 s56, 229376, 0
    s_cselect_b32 s6, 7, s6
    s_sub_u32 s43, s43, s56
    s_add_u32 m0, s42, 81920
    s_nop 0
    buffer_load_dwordx4 v13, s[20:23], s43 offen lds
    s_add_u32 s43, s43, 0x2000
    s_add_u32 m0, s42, 90112
    s_nop 0
    buffer_load_dwordx4 v13, s[20:23], s43 offen lds
    s_add_u32 s43, s43, 0x6000
    s_sub_u32 s6, s6, 1
    s_cmp_eq_u32 s6, 0
    s_cselect_b32 s56, 229376, 0
    s_cselect_b32 s6, 7, s6
    s_sub_u32 s43, s43, s56
    s_add_u32 m0, s42, 98304
    s_nop 0
    buffer_load_dwordx4 v13, s[20:23], s43 offen lds
    s_add_u32 s43, s43, 0x2000
    s_add_u32 m0, s42, 106496
    s_nop 0
    buffer_load_dwordx4 v13, s[20:23], s43 offen lds
    s_add_u32 s43, s43, 0x6000
    s_sub_u32 s6, s6, 1
    s_cmp_eq_u32 s6, 0
    s_cselect_b32 s56, 229376, 0
    s_cselect_b32 s6, 7, s6
    s_sub_u32 s43, s43, s56
    global_load_dword v17, v19, s[32:33]
    s_sub_u32 s57, s35, 28
    s_mul_i32 s57, s57, 229376
    buffer_load_dword v101, v102, s[20:23], s57 offen sc1
    s_add_u32 s57, s57, 131072
    s_cmp_ge_u32 s36, 6
    s_cbranch_scc1 L_tWA
    buffer_load_dword v101, v102, s[20:23], s57 offen sc1
L_tWA:
    s_sub_u32 s57, s35, 28
    s_mul_i32 s57, s57, 229376
    s_add_u32 s57, s57, 917504
    buffer_load_dword v101, v102, s[20:23], s57 offen sc1
    s_add_u32 s57, s57, 131072
    s_cmp_ge_u32 s36, 6
    s_cbranch_scc1 L_tWB
    buffer_load_dword v101, v102, s[20:23], s57 offen sc1
L_tWB:
    s_lshl_b32 s57, s101, 15
    s_sub_u32 s57, s38, s57
    s_add_u32 m0, s42, 147456
    s_add_u32 s56, s38, 0
    buffer_load_dwordx4 v13, s[20:23], s56 offen lds
    s_add_u32 m0, s42, 155648
    s_add_u32 s56, s38, 8192
    buffer_load_dwordx4 v13, s[20:23], s56 offen lds
    s_add_u32 m0, s42, 0
    s_add_u32 s56, s57, 196608
    buffer_load_dwordx4 v13, s[20:23], s56 offen lds
    s_add_u32 m0, s42, 8192
    s_add_u32 s56, s57, 204800
    buffer_load_dwordx4 v13, s[20:23], s56 offen lds
    s_add_u32 m0, s42, 16384
    s_add_u32 s56, s38, 98304
    buffer_load_dwordx4 v13, s[20:23], s56 offen lds
    s_add_u32 m0, s42, 24576
    s_add_u32 s56, s38, 106496
    buffer_load_dwordx4 v13, s[20:23], s56 offen lds
    s_waitcnt vmcnt(8)
    s_barrier
    ds_read_b64_tr_b16 v[128:129], v4 offset:32768
    ds_read_b64_tr_b16 v[130:131], v4 offset:40960
    ds_read_b64_tr_b16 v[132:133], v5 offset:32768
    ds_read_b64_tr_b16 v[134:135], v5 offset:40960
    ds_read_b64_tr_b16 v[136:137], v6 offset:32768
    ds_read_b64_tr_b16 v[138:139], v6 offset:40960
    ds_read_b64_tr_b16 v[140:141], v7 offset:32768
    ds_read_b64_tr_b16 v[142:143], v7 offset:40960
    s_waitcnt lgkmcnt(8)
    ds_read_b64_tr_b16 v[144:145], v4 offset:49152
    ds_read_b64_tr_b16 v[146:147], v4 offset:57344
    ds_read_b64_tr_b16 v[148:149], v5 offset:49152
    ds_read_b64_tr_b16 v[150:151], v5 offset:57344
    ds_read_b64_tr_b16 v[152:153], v6 offset:49152
    ds_read_b64_tr_b16 v[154:155], v6 offset:57344
    ds_read_b64_tr_b16 v[156:157], v7 offset:49152
    ds_read_b64_tr_b16 v[158:159], v7 offset:57344
    s_waitcnt lgkmcnt(8)
    ds_read_b64_tr_b16 v[32:33], v26 offset:0
    ds_read_b64_tr_b16 v[34:35], v26 offset:8192
    ds_read_b64_tr_b16 v[36:37], v27 offset:0
    ds_read_b64_tr_b16 v[38:39], v27 offset:8192
    ds_read_b64_tr_b16 v[40:41], v28 offset:0
    ds_read_b64_tr_b16 v[42:43], v28 offset:8192
    ds_read_b64_tr_b16 v[44:45], v29 offset:0
    ds_read_b64_tr_b16 v[46:47], v29 offset:8192
    s_waitcnt lgkmcnt(8)
    ds_read_b64_tr_b16 v[48:49], v26 offset:16384
    ds_read_b64_tr_b16 v[50:51], v26 offset:24576
    ds_read_b64_tr_b16 v[52:53], v27 offset:16384
    ds_read_b64_tr_b16 v[54:55], v27 offset:24576
    ds_read_b64_tr_b16 v[56:57], v28 offset:16384
    ds_read_b64_tr_b16 v[58:59], v28 offset:24576
    ds_read_b64_tr_b16 v[60:61], v29 offset:16384
    ds_read_b64_tr_b16 v[62:63], v29 offset:24576
    s_waitcnt lgkmcnt(8)
    ds_read_b64_tr_b16 v[160:161], v26 offset:32768
    ds_read_b64_tr_b16 v[162:163], v26 offset:40960
    ds_read_b64_tr_b16 v[164:165], v27 offset:32768
    ds_read_b64_tr_b16 v[166:167], v27 offset:40960
    ds_read_b64_tr_b16 v[168:169], v28 offset:32768
    ds_read_b64_tr_b16 v[170:171], v28 offset:40960
    ds_read_b64_tr_b16 v[172:173], v29 offset:32768
    ds_read_b64_tr_b16 v[174:175], v29 offset:40960
    s_waitcnt lgkmcnt(8)
    s_waitcnt lgkmcnt(0)
    s_barrier
    s_add_u32 m0, s42, 32768
    s_nop 0
    buffer_load_dwordx4 v13, s[20:23], s43 offen lds
    s_add_u32 s43, s43, 0x2000
    s_add_u32 m0, s42, 40960
    s_nop 0
    buffer_load_dwordx4 v13, s[20:23], s43 offen lds
    s_add_u32 s43, s43, 0x6000
    s_sub_u32 s6, s6, 1
    s_cmp_eq_u32 s6, 0
    s_cselect_b32 s56, 229376, 0
    s_cselect_b32 s6, 7, s6
    s_sub_u32 s43, s43, s56
    s_add_u32 m0, s42, 49152
    s_nop 0
    buffer_load_dwordx4 v13, s[20:23], s43 offen lds
    s_add_u32 s43, s43, 0x2000
    s_add_u32 m0, s42, 57344
    s_nop 0
    buffer_load_dwordx4 v13, s[20:23], s43 offen lds
    s_mov_b32 s43, s38
    s_lshl_b32 s6, s101, 15
    s_add_u32 s43, s43, 0x2000
    s_add_u32 s43, s43, 0xe000
    s_add_u32 m0, s42, 65536
    s_nop 0
    buffer_load_dwordx4 v13, s[20:23], s43 offen lds
    s_add_u32 s43, s43, 0x2000
    s_add_u32 m0, s42, 73728
    s_nop 0
    buffer_load_dwordx4 v13, s[20:23], s43 offen lds
    s_add_u32 s43, s43, 0xe000
    s_add_u32 m0, s42, 81920
    s_nop 0
    buffer_load_dwordx4 v13, s[20:23], s43 offen lds
    s_add_u32 s43, s43, 0x2000
    s_add_u32 m0, s42, 90112
    s_nop 0
    buffer_load_dwordx4 v13, s[20:23], s43 offen lds
    s_add_u32 s43, s43, 0xe000
    s_sub_u32 s43, s43, s6
    s_add_u32 s43, s43, 0x2000
    s_add_u32 s43, s43, 0xfffd6000
    s_add_u32 s43, s43, s6
    s_add_u32 m0, s42, 98304
    s_nop 0
    buffer_load_dwordx4 v13, s[20:23], s43 offen lds
    s_add_u32 s43, s43, 0x2000
    s_add_u32 m0, s42, 106496
    s_nop 0
    buffer_load_dwordx4 v13, s[20:23], s43 offen lds
    s_add_u32 s43, s43, 0xe000
    s_add_u32 s43, s43, 0x2000
    s_add_u32 s43, s43, 0xe000
    s_mov_b32 s51, 1048576
L_go_b:
    v_readfirstlane_b32 s56, v17
    s_cmp_eq_u32 s56, 1
    s_cbranch_scc1 L_go_ok_b
    global_load_dword v17, v19, s[32:33] sc1
    s_waitcnt vmcnt(0)
    s_sub_u32 s51, s51, 1
    s_cmp_lg_u32 s51, 0
    s_cbranch_scc1 L_go_b
L_go_ok_b:
    s_cmp_lg_u32 s36, 0
    s_cbranch_scc1 L_bc_done
    s_lshl_b32 s56, s34, 2
    s_add_u32 s56, s56, s35
    s_lshl_b32 s56, s56, 7
    s_add_u32 s56, s56, 7344640
    s_mov_b32 s51, 1048576
L_bc:
    buffer_load_dword v16, v19, s[28:31], s56 offen sc1
    s_waitcnt vmcnt(0)
    v_readfirstlane_b32 s57, v16
    s_cmp_eq_u32 s57, 1
    s_cbranch_scc1 L_bc_done
    s_sub_u32 s51, s51, 1
    s_cmp_lg_u32 s51, 0
    s_cbranch_scc1 L_bc
L_bc_done:
    s_waitcnt vmcnt(0)
    s_barrier
    buffer_load_dword v16, v15, s[28:31], s50 offen offset:0 sc1
    s_mov_b32 s51, 1048576
L_poll_b:
    s_waitcnt vmcnt(0)
    v_cmp_ne_u32 vcc, 1, v16
    s_cbranch_vccz L_ready_b
    buffer_load_dword v16, v15, s[28:31], s50 offen offset:0 sc1
    s_sub_u32 s51, s51, 1
    s_cmp_lg_u32 s51, 0
    s_cbranch_scc1 L_poll_b
L_ready_b:
    buffer_load_dwordx4 v[176:179], v14, s[28:31], s3 offen offset:0 sc1
    buffer_load_dwordx4 v[180:183], v14, s[28:31], s3 offen offset:1024 sc1
    buffer_load_dwordx4 v[184:187], v14, s[28:31], s7 offen offset:0 sc1
    buffer_load_dwordx4 v[188:191], v14, s[28:31], s7 offen offset:1024 sc1
    buffer_load_dwordx4 v[192:195], v14, s[28:31], s48 offen offset:0 sc1
    buffer_load_dwordx4 v[196:199], v14, s[28:31], s48 offen offset:1024 sc1
    buffer_load_dwordx4 v[200:203], v14, s[28:31], s99 offen offset:0 sc1
    buffer_load_dwordx4 v[204:207], v14, s[28:31], s99 offen offset:1024 sc1
    buffer_load_dwordx4 v[208:211], v14, s[28:31], s100 offen offset:0 sc1
    buffer_load_dwordx4 v[212:215], v14, s[28:31], s100 offen offset:1024 sc1
    s_waitcnt vmcnt(0)
    s_branch L_join
.section .rodata,"a"
.p2align 6
.amdhsa_kernel standalone__glu_gated_reglu__prompt_kernel
  .amdhsa_next_free_vgpr 256
  .amdhsa_next_free_sgpr 102
  .amdhsa_accum_offset 256
  .amdhsa_group_segment_fixed_size 0
  .amdhsa_kernarg_size 56
  .amdhsa_user_sgpr_count 2
  .amdhsa_user_sgpr_kernarg_segment_ptr 1
  .amdhsa_system_sgpr_workgroup_id_x 1
.end_amdhsa_kernel
```
